```python
import torch

def _softmax(x, axis=-1):
    return torch.softmax(x, dim=axis)
def _gelu(x):
    return torch.nn.functional.gelu(x, approximate="tanh")
def _silu(x):
    return torch.nn.functional.silu(x)
def _sigmoid(x):
    return torch.sigmoid(x)
def _layernorm(x, axis=-1, eps=1e-5):
    m = x.mean(dim=axis, keepdim=True)
    v = x.var(dim=axis, keepdim=True, unbiased=False)
    return (x - m) / torch.sqrt(v + eps)
def _scatter_add(tgt, idx, src, axis=0):
    return tgt.clone().index_add_(axis, idx, src)
def _segment_sum(src, seg, n):
    out = torch.zeros((n,) + src.shape[1:], dtype=src.dtype)
    return out.index_add_(0, seg, src)
def _pad(x, pw):
    flat = tuple(v for pair in reversed(pw) for v in pair)
    return torch.nn.functional.pad(x, flat)

kernel_name = 'sequential_preLN__sliding_block__mixer_token_mlp__prompt'

def setup_inputs():

    _w = (lambda a: (lambda t: t.to(torch.bfloat16) if t.is_floating_point() else t)(torch.as_tensor(a)))
    def _A_setup():
        B, S, D = 1, 2048, 512
        return {
            "x": _w((lambda *s: torch.randn(*s, dtype=torch.bfloat16) * 0.05)(B, S, D)),
            "wqkv": _w((lambda *s: torch.randn(*s, dtype=torch.bfloat16) * 0.05)(D, 3 * D)),
            "wo": _w((lambda *s: torch.randn(*s, dtype=torch.bfloat16) * 0.05)(D, D)),
        }
    _A_in = _A_setup()

    def _B_setup():
        B, S, D, F = 1, 2048, 512, 1376
        return {
            "x": _w((lambda *s: torch.randn(*s, dtype=torch.bfloat16) * 0.05)(B, S, D)),
            "w1": _w((lambda *s: torch.randn(*s, dtype=torch.bfloat16) * 0.8)(S, F) * (S ** -0.5)),
            "b1": _w((lambda *s: torch.randn(*s, dtype=torch.bfloat16) * 0.8)(F) * 0.02),
            "w2": _w((lambda *s: torch.randn(*s, dtype=torch.bfloat16) * 0.8)(F, S) * (F ** -0.5)),
            "b2": _w((lambda *s: torch.randn(*s, dtype=torch.bfloat16) * 0.8)(S) * 0.02),
        }
    _B_in = _B_setup()

    return {
        "A_x": _A_in["x"],
        "A_wqkv": _A_in["wqkv"],
        "A_wo": _A_in["wo"],
        "B_x": _B_in["x"],
        "B_w1": _B_in["w1"],
        "B_b1": _B_in["b1"],
        "B_w2": _B_in["w2"],
        "B_b2": _B_in["b2"],
    }

def reference(A_x, A_wqkv, A_wo, B_x, B_w1, B_b1, B_w2, B_b2):
    def _A_ref(x, wqkv, wo):
        B, S, D = x.shape
        H = 32; Dh = D // H; W = 256
        qkv = (lambda x, *d: x.permute(*d))((x @ wqkv).reshape(B, S, 3, H, Dh), 2, 0, 3, 1, 4)
        q, k, v = qkv[0], qkv[1], qkv[2]
        scores = torch.einsum("bhqd,bhkd->bhqk", q, k) * (Dh ** -0.5)
        idx = torch.arange(S)
        mask = (idx[:, None] - idx[None, :] >= 0) & (idx[:, None] - idx[None, :] < W)
        scores = torch.where(mask[None, None], scores, -1e9)
        p = _softmax(scores, axis=-1)
        o = torch.einsum("bhqk,bhkd->bhqd", p, v)
        return (lambda x, *d: x.permute(*d))(o, 0, 2, 1, 3).reshape(B, S, D) @ wo

    def _B_ref(x, w1, b1, w2, b2):
        B, S, D = x.shape
        h = _layernorm(x, axis=-1)
        u = torch.einsum("bsd,sf->bdf", h, w1) + b1
        u = _gelu(u)
        y = torch.einsum("bdf,fs->bds", u, w2) + b2
        return (lambda x, *d: x.permute(*d))(y, 0, 2, 1)

    x = A_x
    h = x + _A_ref(_layernorm(x, axis=-1), A_wqkv, A_wo)
    h2 = h + _B_ref(_layernorm(h, axis=-1), B_w1, B_b1, B_w2, B_b2)
    return h2
```

```asm
; @launch kernel=sequential_preLN__sliding_block__mixer_token_mlp__prompt_kernel grid=(256,1,1) block=(512,1,1) lds=163840
.amdgcn_target "amdgcn-amd-amdhsa--gfx950"
.text
.globl sequential_preLN__sliding_block__mixer_token_mlp__prompt_kernel
.p2align 8
.type sequential_preLN__sliding_block__mixer_token_mlp__prompt_kernel,@function
sequential_preLN__sliding_block__mixer_token_mlp__prompt_kernel:
    s_cmp_ge_u32 s2, 256
    s_cbranch_scc1 L_end
    s_load_dwordx16 s[64:79], s[0:1], 0
    s_load_dwordx2 s[80:81], s[0:1], 64
    s_load_dwordx2 s[82:83], s[0:1], 80
    s_getpc_b64 s[84:85]
    s_lshr_b32 s49, s2, 3
    v_cmp_gt_u32 vcc, 9, v0
    s_and_b32 s84, s84, 0xffffff00
    v_mov_b32 v251, s49
    v_lshl_add_u32 v251, v0, 5, v251
    v_lshlrev_b32 v251, 7, v251
    v_min_u32 v251, 0x86a4, v251
    s_and_saveexec_b64 s[86:87], vcc
    s_cbranch_execz L_noct
    global_load_dword v251, v251, s[84:85]
L_noct:
    s_mov_b64 exec, -1
    v_lshrrev_b32 v1, 6, v0
    s_nop 0
    v_readfirstlane_b32 s3, v1
    s_and_b32 s48, s2, 7
    s_lshr_b32 s49, s2, 3
    s_lshl_b32 s5, s48, 2
    s_lshr_b32 s50, s49, 3
    s_add_u32 s5, s5, s50
    s_and_b32 s6, s49, 7
    s_and_b32 s7, s3, 3
    v_and_b32 v3, 63, v0
    v_lshlrev_b32 v2, 4, v3
    v_mov_b32 v1, 163584
    s_lshl_b32 s53, s5, 16
    s_lshl_b32 s54, s6, 7
    s_mov_b32 s47, 0x80000
    s_cmp_lt_u32 s3, 4
    s_cbranch_scc1 L_compute
    v_bfe_u32 v4, v0, 3, 3
    v_and_b32 v5, 7, v0
    s_lshl_b32 s55, s7, 4
    v_add_u32 v6, s55, v4
    v_lshrrev_b32 v7, 1, v4
    v_xor_b32 v8, v7, v5
    v_lshlrev_b32 v8, 4, v8
    v_lshl_add_u32 v8, v6, 10, v8
    v_add_u32 v8, s53, v8
    v_xor_b32 v9, 64, v8
    v_add_u32 v9, 7168, v9
    v_lshlrev_b32 v7, 2, v7
    v_and_b32 v7, 4, v7
    v_xor_b32 v7, v7, v5
    v_mul_u32_u24 v10, 3072, v6
    v_lshl_add_u32 v10, v7, 4, v10
    v_add_u32 v12, s54, v10
    v_add_u32 v10, 1024, v12
    v_add_u32 v11, 24576, v12
    v_add_u32 v13, 23552, v12
    s_lshl_b32 s56, s7, 11
    s_lshl_b32 s55, s7, 12
    s_xor_b32 s90, s2, s6
    s_and_b32 s90, s90, 7
    s_xor_b32 s91, s90, 0
    s_xor_b32 s58, s91, s6
    s_lshl_b32 s57, s58, 7
    s_lshl_b32 s91, s91, 13
    s_add_u32 m0, s91, s56
    s_mul_i32 s58, s58, 196608
    s_mov_b32 s14, 2097152
    s_mov_b32 s15, 0x00020000
    s_mov_b32 s18, 1572864
    s_mov_b32 s19, 0x00020000
    s_waitcnt lgkmcnt(0)
    s_mov_b64 s[12:13], s[64:65]
    s_mov_b64 s[16:17], s[66:67]
    buffer_load_dwordx4 v8, s[12:15], s57 offen lds
    buffer_load_dwordx4 v9, s[12:15], s57 offen offset:1024 lds
    s_add_u32 m0, s55, 65536
    s_nop 0
    buffer_load_dwordx4 v10, s[16:19], s58 offen offset:0 lds
    buffer_load_dwordx4 v11, s[16:19], s58 offen offset:1024 lds
    buffer_load_dwordx4 v12, s[16:19], s58 offen offset:2048 lds
    buffer_load_dwordx4 v13, s[16:19], s58 offen offset:3072 lds
    s_lshl_b32 s59, s6, 13
    s_lshl_b32 s60, s7, 11
    s_add_u32 s59, s59, s60
    s_add_u32 s59, s59, s53
    buffer_load_dwordx4 v[20:23], v2, s[12:15], s59 offen
    buffer_load_dwordx4 v[24:27], v2, s[12:15], s59 offen offset:1024
    s_mov_b32 s20, s68
    s_mov_b32 s21, s69
    s_mov_b32 s22, 0x00080000
    s_mov_b32 s23, 0x00020000
    s_mov_b32 s8, s82
    s_mov_b32 s9, s83
    s_mov_b32 s10, 0x00b00000
    s_mov_b32 s11, 0x00020000
    s_mov_b32 s59, 10485760
    s_mov_b64 exec, 1
    buffer_load_dword v28, v2, s[8:11], s59 offen
    s_mov_b64 exec, -1
    s_mov_b32 s24, s72
    s_mov_b32 s25, s73
    s_mov_b32 s26, 0x00560000
    s_mov_b32 s27, 0x00020000
    s_mov_b32 s32, s74
    s_mov_b32 s33, s75
    s_mov_b32 s34, 0x00000ac0
    s_mov_b32 s35, 0x00020000
    s_mov_b32 s28, s76
    s_mov_b32 s29, s77
    s_mov_b32 s30, 0x00560000
    s_mov_b32 s31, 0x00020000
    s_and_b32 s50, s48, 1
    s_lshl_b32 s50, s50, 2
    s_and_b32 s51, s49, 3
    s_add_u32 s44, s50, s51
    s_lshr_b32 s50, s48, 1
    s_lshr_b32 s51, s49, 2
    s_min_u32 s52, s50, 1
    s_add_u32 s51, s51, s52
    s_mul_i32 s50, s50, 7
    s_add_u32 s45, s50, s51
    s_cmp_ge_u32 s51, 8
    s_cselect_b32 s45, 64, s45
    s_mov_b32 s40, s80
    s_mov_b32 s41, s81
    s_mov_b32 s42, 0x00200000
    s_mov_b32 s43, 0x00020000
    v_mov_b32 v16, 0
    v_mov_b32 v17, 0
    v_mov_b32 v18, 0
    v_mov_b32 v19, 0
    s_mov_b32 s59, 0x3f803f80
    s_mov_b32 s61, 0xffff0000
    v_lshlrev_b32 v6, 4, v7
    v_lshl_add_u32 v6, v4, 10, v6
    s_lshl_b32 s60, s7, 17
    s_add_u32 s60, s60, s54
    v_add_u32 v36, s60, v6
    v_add_u32 v37, 7168, v36
    v_add_u32 v38, 14336, v36
    v_add_u32 v39, 21504, v36
    s_mul_i32 s60, s45, 96
    v_add_u32 v5, 0, v3
    v_mul_u32_u24 v6, 10923, v5
    v_lshrrev_b32 v6, 16, v6
    v_mul_u32_u24 v7, 6, v6
    v_sub_u32 v7, v5, v7
    v_mul_u32_u24 v6, 2752, v6
    v_lshl_add_u32 v6, v7, 4, v6
    v_add_u32 v40, s60, v6
    v_add_u32 v5, 64, v3
    v_mul_u32_u24 v6, 10923, v5
    v_lshrrev_b32 v6, 16, v6
    v_mul_u32_u24 v7, 6, v6
    v_sub_u32 v7, v5, v7
    v_mul_u32_u24 v6, 2752, v6
    v_lshl_add_u32 v6, v7, 4, v6
    v_add_u32 v41, s60, v6
    v_subrev_u32 v41, 1024, v41
    v_add_u32 v5, 128, v3
    v_mul_u32_u24 v6, 10923, v5
    v_lshrrev_b32 v6, 16, v6
    v_mul_u32_u24 v7, 6, v6
    v_sub_u32 v7, v5, v7
    v_mul_u32_u24 v6, 2752, v6
    v_lshl_add_u32 v6, v7, 4, v6
    v_add_u32 v42, s60, v6
    v_subrev_u32 v42, 2048, v42
    v_add_u32 v30, s7, v1
    v_mov_b32 v31, 0x80
    v_and_b32 v14, 3, v0
    s_lshl_b32 s92, s7, 2
    v_add_u32 v14, s92, v14
    v_mul_u32_u24 v14, 3072, v14
    v_bfe_u32 v15, v0, 2, 2
    v_lshl_add_u32 v14, v15, 10, v14
    s_lshr_b32 s92, s2, 3
    s_mul_i32 s92, s92, 49152
    s_mov_b64 exec, 0xfff
    buffer_load_dword v14, v14, s[16:19], s92 offen offset:384
    v_lshlrev_b32 v15, 6, v2
    s_lshr_b32 s92, s2, 3
    s_lshl_b32 s92, s92, 2
    s_add_u32 s92, s92, s7
    s_lshl_b32 s92, s92, 12
    s_mov_b64 exec, 0xf
    buffer_load_dword v15, v15, s[20:23], s92 offen offset:384
    s_mov_b64 exec, -1
    s_lshl_b32 s92, s2, 2
    s_add_u32 s92, s92, s7
    s_lshl_b32 s93, s92, 9
    s_mul_i32 s92, s92, 384
    s_add_u32 s92, s92, 10485760
    v_lshlrev_b32 v34, 3, v2
    s_mov_b64 exec, 7
    buffer_load_dword v35, v34, s[8:11], s92 offen sc1
    s_mov_b64 exec, 15
    buffer_load_dword v43, v34, s[20:23], s93 offen
    s_mov_b64 exec, 1
    s_mov_b32 s36, s78
    s_mov_b32 s37, s79
    s_mov_b32 s38, 0x00001000
    s_mov_b32 s39, 0x00020000
    s_lshl_b32 s92, s5, 7
    buffer_load_dword v29, v34, s[36:39], s92 offen
    s_mul_i32 s92, s45, 96
    s_lshl_b32 s93, s7, 5
    s_add_u32 s92, s92, s93
    buffer_load_dword v34, v34, s[32:35], s92 offen
    s_mov_b64 exec, -1
    s_xor_b32 s91, s90, 1
    s_xor_b32 s58, s91, s6
    s_lshl_b32 s57, s58, 7
    s_lshl_b32 s91, s91, 13
    s_add_u32 m0, s91, s56
    s_mul_i32 s58, s58, 196608
    buffer_load_dwordx4 v8, s[12:15], s57 offen lds
    buffer_load_dwordx4 v9, s[12:15], s57 offen offset:1024 lds
    s_add_u32 m0, s55, 81920
    s_nop 0
    buffer_load_dwordx4 v10, s[16:19], s58 offen offset:0 lds
    buffer_load_dwordx4 v11, s[16:19], s58 offen offset:1024 lds
    buffer_load_dwordx4 v12, s[16:19], s58 offen offset:2048 lds
    buffer_load_dwordx4 v13, s[16:19], s58 offen offset:3072 lds
    s_waitcnt vmcnt(15)
    s_barrier
    s_xor_b32 s91, s90, 2
    s_xor_b32 s58, s91, s6
    s_lshl_b32 s57, s58, 7
    s_lshl_b32 s91, s91, 13
    s_add_u32 m0, s91, s56
    s_mul_i32 s58, s58, 196608
    buffer_load_dwordx4 v8, s[12:15], s57 offen lds
    buffer_load_dwordx4 v9, s[12:15], s57 offen offset:1024 lds
    s_add_u32 m0, s55, 98304
    s_nop 0
    buffer_load_dwordx4 v10, s[16:19], s58 offen offset:0 lds
    buffer_load_dwordx4 v11, s[16:19], s58 offen offset:1024 lds
    buffer_load_dwordx4 v12, s[16:19], s58 offen offset:2048 lds
    buffer_load_dwordx4 v13, s[16:19], s58 offen offset:3072 lds
    s_waitcnt vmcnt(18)
    v_dot2c_f32_bf16 v16, s59, v20
    v_dot2c_f32_bf16 v18, v20, v20
    v_dot2c_f32_bf16 v17, s59, v24
    v_dot2c_f32_bf16 v19, v24, v24
    v_dot2c_f32_bf16 v16, s59, v21
    v_dot2c_f32_bf16 v18, v21, v21
    v_dot2c_f32_bf16 v17, s59, v25
    v_dot2c_f32_bf16 v19, v25, v25
    v_dot2c_f32_bf16 v16, s59, v22
    v_dot2c_f32_bf16 v18, v22, v22
    v_dot2c_f32_bf16 v17, s59, v26
    v_dot2c_f32_bf16 v19, v26, v26
    v_dot2c_f32_bf16 v16, s59, v23
    v_dot2c_f32_bf16 v18, v23, v23
    v_dot2c_f32_bf16 v17, s59, v27
    v_dot2c_f32_bf16 v19, v27, v27
    v_readfirstlane_b32 s4, v28
    s_nop 0
    s_mul_i32 s4, s4, 0x41c64e6d
    s_add_u32 s4, s4, 0x3c6ef35f
    s_getreg_b32 s62, hwreg(HW_REG_XCC_ID, 0, 4)
    s_and_b32 s63, s4, 0xfffffff0
    s_or_b32 s62, s62, s63
    v_permlane32_swap_b32 v16, v17
    v_permlane32_swap_b32 v18, v19
    v_add_f32 v16, v16, v17
    v_add_f32 v18, v18, v19
    v_mov_b32 v17, v16
    v_mov_b32 v19, v18
    v_mov_b32 v28, s4
    v_mov_b32 v21, s62
    v_permlane16_swap_b32 v16, v17
    v_permlane16_swap_b32 v18, v19
    v_add_f32 v16, v16, v17
    v_add_f32 v18, v18, v19
    s_nop 0
    v_add_f32_dpp v16, v16, v16 quad_perm:[1,0,3,2] row_mask:0xf bank_mask:0xf
    v_add_f32_dpp v18, v18, v18 quad_perm:[1,0,3,2] row_mask:0xf bank_mask:0xf
    s_nop 0
    v_add_f32_dpp v16, v16, v16 quad_perm:[2,3,0,1] row_mask:0xf bank_mask:0xf
    v_add_f32_dpp v18, v18, v18 quad_perm:[2,3,0,1] row_mask:0xf bank_mask:0xf
    s_nop 0
    v_add_f32_dpp v16, v16, v16 row_half_mirror row_mask:0xf bank_mask:0xf
    v_add_f32_dpp v18, v18, v18 row_half_mirror row_mask:0xf bank_mask:0xf
    s_nop 0
    v_add_f32_dpp v16, v16, v16 row_mirror row_mask:0xf bank_mask:0xf
    v_add_f32_dpp v18, v18, v18 row_mirror row_mask:0xf bank_mask:0xf
    v_mul_f32 v16, 0xbb000000, v16
    v_mul_f32 v18, 0x3b000000, v18
    v_fma_f32 v18, -v16, v16, v18
    v_max_f32 v18, 0, v18
    v_add_f32 v18, 0x3727c5ac, v18
    v_rsq_f32 v22, v18
    v_cvt_pk_bf16_f32 v17, v16, 0
    v_lshlrev_b32 v17, 16, v17
    v_sub_f32 v17, v16, v17
    v_cvt_pk_bf16_f32 v20, v16, v17
    v_mov_b32 v23, s62
    v_lshrrev_b32 v24, 5, v2
    s_lshl_b32 s62, s5, 10
    s_add_u32 s62, s62, 10616832
    s_lshl_b32 s63, s7, 5
    s_add_u32 s63, s63, s54
    s_add_u32 s63, s63, s62
    s_mov_b32 exec_lo, 1
    s_mov_b32 exec_hi, 1
    buffer_store_dwordx4 v[20:23], v24, s[8:11], s63 offen sc1
    s_mov_b64 exec, -1
    s_waitcnt vmcnt(7)
    s_barrier
    s_xor_b32 s91, s90, 3
    s_xor_b32 s58, s91, s6
    s_lshl_b32 s57, s58, 7
    s_lshl_b32 s91, s91, 13
    s_add_u32 m0, s91, s56
    s_mul_i32 s58, s58, 196608
    buffer_load_dwordx4 v8, s[12:15], s57 offen lds
    buffer_load_dwordx4 v9, s[12:15], s57 offen offset:1024 lds
    s_add_u32 m0, s55, 114688
    s_nop 0
    buffer_load_dwordx4 v10, s[16:19], s58 offen offset:0 lds
    buffer_load_dwordx4 v11, s[16:19], s58 offen offset:1024 lds
    buffer_load_dwordx4 v12, s[16:19], s58 offen offset:2048 lds
    buffer_load_dwordx4 v13, s[16:19], s58 offen offset:3072 lds
    s_waitcnt vmcnt(7)
    s_barrier
    s_xor_b32 s91, s90, 4
    s_xor_b32 s58, s91, s6
    s_lshl_b32 s57, s58, 7
    s_lshl_b32 s91, s91, 13
    s_add_u32 m0, s91, s56
    s_mul_i32 s58, s58, 196608
    buffer_load_dwordx4 v8, s[12:15], s57 offen lds
    buffer_load_dwordx4 v9, s[12:15], s57 offen offset:1024 lds
    s_add_u32 m0, s55, 65536
    s_nop 0
    buffer_load_dwordx4 v10, s[16:19], s58 offen offset:0 lds
    buffer_load_dwordx4 v11, s[16:19], s58 offen offset:1024 lds
    buffer_load_dwordx4 v12, s[16:19], s58 offen offset:2048 lds
    buffer_load_dwordx4 v13, s[16:19], s58 offen offset:3072 lds
    s_waitcnt vmcnt(6)
    s_barrier
    s_xor_b32 s91, s90, 5
    s_xor_b32 s58, s91, s6
    s_lshl_b32 s57, s58, 7
    s_lshl_b32 s91, s91, 13
    s_add_u32 m0, s91, s56
    s_mul_i32 s58, s58, 196608
    buffer_load_dwordx4 v8, s[12:15], s57 offen lds
    buffer_load_dwordx4 v9, s[12:15], s57 offen offset:1024 lds
    s_add_u32 m0, s55, 81920
    s_nop 0
    buffer_load_dwordx4 v10, s[16:19], s58 offen offset:0 lds
    buffer_load_dwordx4 v11, s[16:19], s58 offen offset:1024 lds
    buffer_load_dwordx4 v12, s[16:19], s58 offen offset:2048 lds
    buffer_load_dwordx4 v13, s[16:19], s58 offen offset:3072 lds
    s_waitcnt vmcnt(6)
    s_barrier
    s_xor_b32 s91, s90, 6
    s_xor_b32 s58, s91, s6
    s_lshl_b32 s57, s58, 7
    s_lshl_b32 s91, s91, 13
    s_add_u32 m0, s91, s56
    s_mul_i32 s58, s58, 196608
    buffer_load_dwordx4 v8, s[12:15], s57 offen lds
    buffer_load_dwordx4 v9, s[12:15], s57 offen offset:1024 lds
    s_add_u32 m0, s55, 98304
    s_nop 0
    buffer_load_dwordx4 v10, s[16:19], s58 offen offset:0 lds
    buffer_load_dwordx4 v11, s[16:19], s58 offen offset:1024 lds
    buffer_load_dwordx4 v12, s[16:19], s58 offen offset:2048 lds
    buffer_load_dwordx4 v13, s[16:19], s58 offen offset:3072 lds
    s_waitcnt vmcnt(6)
    s_barrier
    s_xor_b32 s91, s90, 7
    s_xor_b32 s58, s91, s6
    s_lshl_b32 s57, s58, 7
    s_lshl_b32 s91, s91, 13
    s_add_u32 m0, s91, s56
    s_mul_i32 s58, s58, 196608
    buffer_load_dwordx4 v8, s[12:15], s57 offen lds
    buffer_load_dwordx4 v9, s[12:15], s57 offen offset:1024 lds
    s_add_u32 m0, s55, 114688
    s_nop 0
    buffer_load_dwordx4 v10, s[16:19], s58 offen offset:0 lds
    buffer_load_dwordx4 v11, s[16:19], s58 offen offset:1024 lds
    buffer_load_dwordx4 v12, s[16:19], s58 offen offset:2048 lds
    buffer_load_dwordx4 v13, s[16:19], s58 offen offset:3072 lds
    buffer_load_dwordx4 v[24:27], v2, s[8:11], s62 offen sc1
    s_waitcnt vmcnt(7)
    s_barrier
    v_subrev_u32 v10, 1024, v10
    v_subrev_u32 v11, 1024, v11
    s_add_u32 m0, s55, 65536
    s_xor_b32 s91, s90, 0
    s_xor_b32 s58, s91, s6
    s_mul_i32 s58, s58, 196608
    buffer_load_dwordx4 v10, s[16:19], s58 offen offset:0 lds
    buffer_load_dwordx4 v11, s[16:19], s58 offen offset:1024 lds
    s_add_u32 m0, s55, 67584
    s_xor_b32 s91, s90, 1
    s_xor_b32 s58, s91, s6
    s_mul_i32 s58, s58, 196608
    buffer_load_dwordx4 v10, s[16:19], s58 offen offset:0 lds
    buffer_load_dwordx4 v11, s[16:19], s58 offen offset:1024 lds
    s_waitcnt vmcnt(4)
    s_lshr_b32 s63, s4, 4
    s_branch L_fxc
L_fxp:
    buffer_load_dwordx4 v[24:27], v2, s[8:11], s62 offen sc1
    s_waitcnt vmcnt(0)
L_fxc:
    v_lshrrev_b32 v16, 4, v25
    v_lshrrev_b32 v17, 4, v27
    v_cmp_ne_u32 vcc, s63, v16
    v_cmp_ne_u32 s[50:51], s63, v17
    s_nop 0
    s_or_b64 vcc, vcc, s[50:51]
    s_cbranch_scc0 lwd_1
    s_sub_u32 s47, s47, 1
    s_cbranch_scc0 L_fxp
    s_mov_b32 s47, 0
lwd_1:
    v_readfirstlane_b32 s63, v25
    v_lshrrev_b32 v16, 2, v2
    v_add_u32 v16, 147456, v16
    v_cmp_ne_u32 vcc, s63, v25
    v_lshrrev_b32 v17, 1, v2
    v_add_u32 v17, 147712, v17
    v_and_b32 v25, 0xffff, v24
    ds_write_b32 v16, v26
    ds_write_b64 v17, v[24:25]
    s_cmp_eq_u64 vcc, 0
    s_cselect_b32 s63, 2, 1
    v_mov_b32 v18, s63
    ds_write_b32 v1, v18 offset:12
    ds_write_b32 v1, v28 offset:76
    s_waitcnt vmcnt(5)
    s_waitcnt lgkmcnt(0)
    s_barrier
    s_add_u32 m0, s55, 81920
    s_xor_b32 s91, s90, 2
    s_xor_b32 s58, s91, s6
    s_mul_i32 s58, s58, 196608
    buffer_load_dwordx4 v10, s[16:19], s58 offen offset:0 lds
    buffer_load_dwordx4 v11, s[16:19], s58 offen offset:1024 lds
    s_add_u32 m0, s55, 83968
    s_xor_b32 s91, s90, 3
    s_xor_b32 s58, s91, s6
    s_mul_i32 s58, s58, 196608
    buffer_load_dwordx4 v10, s[16:19], s58 offen offset:0 lds
    buffer_load_dwordx4 v11, s[16:19], s58 offen offset:1024 lds
    s_waitcnt vmcnt(4)
    ds_write_b8 v30, v31 offset:160
sp_2:
    ds_read_b32 v3, v1 offset:124
    s_sub_u32 s47, s47, 1
    s_cselect_b64 s[98:99], -1, 0
    s_andn2_b32 s47, s47, s98
    s_waitcnt lgkmcnt(0)
    v_readfirstlane_b32 s48, v3
    s_nop 0
    s_or_b32 s48, s48, s98
    s_cmp_lt_u32 s48, 0x80808080
    s_cbranch_scc1 sp_2
    s_add_u32 m0, s55, 98304
    s_xor_b32 s91, s90, 4
    s_xor_b32 s58, s91, s6
    s_mul_i32 s58, s58, 196608
    buffer_load_dwordx4 v10, s[16:19], s58 offen offset:0 lds
    buffer_load_dwordx4 v11, s[16:19], s58 offen offset:1024 lds
    s_add_u32 m0, s55, 100352
    s_xor_b32 s91, s90, 5
    s_xor_b32 s58, s91, s6
    s_mul_i32 s58, s58, 196608
    buffer_load_dwordx4 v10, s[16:19], s58 offen offset:0 lds
    buffer_load_dwordx4 v11, s[16:19], s58 offen offset:1024 lds
    s_add_u32 m0, s55, 114688
    s_xor_b32 s91, s90, 6
    s_xor_b32 s58, s91, s6
    s_mul_i32 s58, s58, 196608
    buffer_load_dwordx4 v10, s[16:19], s58 offen offset:0 lds
    buffer_load_dwordx4 v11, s[16:19], s58 offen offset:1024 lds
    s_add_u32 m0, s55, 116736
    s_xor_b32 s91, s90, 7
    s_xor_b32 s58, s91, s6
    s_mul_i32 s58, s58, 196608
    buffer_load_dwordx4 v10, s[16:19], s58 offen offset:0 lds
    buffer_load_dwordx4 v11, s[16:19], s58 offen offset:1024 lds
    s_waitcnt vmcnt(8)
    ds_write_b8 v30, v31 offset:164
    s_waitcnt vmcnt(4)
    ds_write_b8 v30, v31 offset:168
    s_waitcnt vmcnt(0)
    ds_write_b8 v30, v31 offset:172
    v_and_b32 v14, 7, v0
    v_lshlrev_b32 v14, 7, v14
    v_bfe_u32 v15, v0, 3, 1
    v_lshl_add_u32 v15, v15, 15, v14
    s_lshl_b32 s50, s6, 2
    s_add_u32 s50, s50, s7
    s_lshl_b32 s50, s50, 10
    s_add_u32 s50, s50, s53
    s_add_u32 s50, s50, 4194304
    s_lshl_b32 s51, s5, 14
    s_and_b32 s52, s7, 1
    s_lshl_b32 s52, s52, 13
    s_add_u32 s51, s51, s52
    s_lshl_b32 s52, s6, 10
    s_add_u32 s51, s51, s52
    s_lshr_b32 s52, s7, 1
    s_lshl_b32 s52, s52, 9
    s_add_u32 s51, s51, s52
    s_add_u32 s51, s51, 9961472
    s_mov_b64 exec, 0xffff
    buffer_load_dword v15, v15, s[8:11], s50 offen sc1
    s_mov_b64 exec, 0xf
    buffer_load_dword v14, v14, s[8:11], s51 offen sc1
    s_lshl_b32 s51, s5, 7
    s_add_u32 s51, s51, 10493952
    buffer_load_dword v16, v2, s[8:11], s51 offen sc1
    s_mov_b64 exec, -1
    s_lshl_b32 s62, s5, 3
    s_add_u32 s62, s62, s6
    s_lshl_b32 s63, s62, 14
    s_add_u32 s63, s63, s55
    s_lshl_b32 s62, s62, 9
    s_lshl_b32 s57, s7, 7
    s_add_u32 s62, s62, s57
    s_add_u32 s62, s62, 10747904
    v_and_b32 v5, 63, v0
    s_min_u32 s57, s5, 4
    s_lshl_b32 s57, s57, 1
    s_sub_u32 s57, s57, 1
    v_min_u32 v7, s57, v5
    v_lshlrev_b32 v7, 2, v7
    s_lshl_b32 s57, s7, 2
    v_add_u32 v32, s57, v1
    s_lshl_b32 s58, s7, 14
    s_add_u32 s58, s58, 8192
    v_add_u32 v33, s58, v2
bw_3:
    ds_read_b32 v3, v1 offset:112
    s_waitcnt lgkmcnt(0)
    v_readfirstlane_b32 s48, v3
    s_nop 0
    s_cmp_lg_u32 s48, 0x80808080
    s_cbranch_scc0 lwd_4
    s_sleep 1
    s_sub_u32 s47, s47, 1
    s_cbranch_scc0 bw_3
    s_mov_b32 s47, 0
lwd_4:
    s_cmp_eq_u32 s5, 0
    s_cbranch_scc1 L_nopoll
pl_5:
    buffer_load_dword v3, v7, s[8:11], s62 offen sc1
    s_sub_u32 s47, s47, 1
    s_cselect_b64 s[98:99], -1, 0
    s_andn2_b32 s47, s47, s98
    s_waitcnt vmcnt(0)
    v_cmp_ne_u32 vcc, s4, v3
    s_nop 0
    s_andn2_b64 vcc, vcc, s[98:99]
    s_cbranch_scc1 pl_5
L_nopoll:
    s_add_u32 m0, s58, 0
    s_sub_u32 s57, s63, 131072
    s_cselect_b32 s57, s63, s57
    buffer_load_dwordx4 v2, s[8:11], s57 offen offset:2048 sc1 lds
    buffer_load_dwordx4 v2, s[8:11], s57 offen offset:0 sc1 lds
    buffer_load_dwordx4 v2, s[8:11], s57 offen offset:3072 sc1 lds
    buffer_load_dwordx4 v2, s[8:11], s57 offen offset:1024 sc1 lds
    s_add_u32 m0, s58, 4096
    s_sub_u32 s57, s63, 262144
    s_cselect_b32 s57, s63, s57
    buffer_load_dwordx4 v2, s[8:11], s57 offen offset:2048 sc1 lds
    buffer_load_dwordx4 v2, s[8:11], s57 offen offset:0 sc1 lds
    buffer_load_dwordx4 v2, s[8:11], s57 offen offset:3072 sc1 lds
    buffer_load_dwordx4 v2, s[8:11], s57 offen offset:1024 sc1 lds
    v_mov_b32 v5, 1
    s_waitcnt vmcnt(4)
    ds_write_b32 v32, v5 offset:176
    s_add_u32 m0, s58, 8192
    s_sub_u32 s57, s63, 393216
    s_cselect_b32 s57, s63, s57
    buffer_load_dwordx4 v2, s[8:11], s57 offen offset:2048 sc1 lds
    buffer_load_dwordx4 v2, s[8:11], s57 offen offset:0 sc1 lds
    buffer_load_dwordx4 v2, s[8:11], s57 offen offset:3072 sc1 lds
    buffer_load_dwordx4 v2, s[8:11], s57 offen offset:1024 sc1 lds
    v_mov_b32 v5, 2
    s_waitcnt vmcnt(4)
    ds_write_b32 v32, v5 offset:176
    s_add_u32 m0, s58, 12288
    s_sub_u32 s57, s63, 524288
    s_cselect_b32 s57, s63, s57
    buffer_load_dwordx4 v2, s[8:11], s57 offen offset:2048 sc1 lds
    buffer_load_dwordx4 v2, s[8:11], s57 offen offset:0 sc1 lds
    buffer_load_dwordx4 v2, s[8:11], s57 offen offset:3072 sc1 lds
    buffer_load_dwordx4 v2, s[8:11], s57 offen offset:1024 sc1 lds
    v_mov_b32 v5, 3
    s_waitcnt vmcnt(4)
    ds_write_b32 v32, v5 offset:176
    s_mov_b32 s57, 0
    buffer_load_dwordx4 v[188:191], v36, s[20:23], s57 offen offset:0
    buffer_load_dwordx4 v[192:195], v37, s[20:23], s57 offen offset:1024
    buffer_load_dwordx4 v[196:199], v38, s[20:23], s57 offen offset:2048
    buffer_load_dwordx4 v[200:203], v39, s[20:23], s57 offen offset:3072
    v_mov_b32 v5, 4
    s_waitcnt vmcnt(4)
    ds_write_b32 v32, v5 offset:176
    s_mov_b32 s57, 32768
    buffer_load_dwordx4 v[204:207], v36, s[20:23], s57 offen offset:0
    buffer_load_dwordx4 v[208:211], v37, s[20:23], s57 offen offset:1024
    buffer_load_dwordx4 v[212:215], v38, s[20:23], s57 offen offset:2048
    buffer_load_dwordx4 v[216:219], v39, s[20:23], s57 offen offset:3072
    s_mov_b32 s57, 65536
    buffer_load_dwordx4 v[220:223], v36, s[20:23], s57 offen offset:0
    buffer_load_dwordx4 v[224:227], v37, s[20:23], s57 offen offset:1024
    buffer_load_dwordx4 v[228:231], v38, s[20:23], s57 offen offset:2048
    buffer_load_dwordx4 v[232:235], v39, s[20:23], s57 offen offset:3072
    s_mov_b32 s57, 98304
    buffer_load_dwordx4 v[236:239], v36, s[20:23], s57 offen offset:0
    buffer_load_dwordx4 v[240:243], v37, s[20:23], s57 offen offset:1024
    buffer_load_dwordx4 v[244:247], v38, s[20:23], s57 offen offset:2048
    buffer_load_dwordx4 v[248:251], v39, s[20:23], s57 offen offset:3072
    s_cmp_ge_u32 s45, 32
    s_cbranch_scc1 L_hidle
    v_mov_b32 v8, v40
    v_mov_b32 v9, v41
    v_mov_b32 v10, v42
    s_mul_i32 s56, s7, 12288
    s_add_u32 s56, s56, 114432
    s_and_b32 s60, s44, 3
    s_lshl_b32 s60, s60, 2
    s_lshr_b32 s61, s44, 2
    s_lshl_b32 s61, s61, 1
    s_add_u32 s60, s60, s61
    s_lshl_b32 s61, s7, 4
    v_bfe_u32 v4, v0, 2, 4
    v_mul_u32_u24 v11, 96, v4
    v_and_b32 v4, 3, v0
    v_lshl_add_u32 v11, v4, 3, v11
    v_add_u32 v11, s56, v11
    s_add_u32 m0, s56, 0
    s_add_u32 s57, s60, 0
    s_and_b32 s57, s57, 15
    s_add_u32 s57, s57, s61
    s_mul_i32 s57, s57, 88064
    buffer_load_dwordx4 v8, s[24:27], s57 offen offset:0 lds
    buffer_load_dwordx4 v9, s[24:27], s57 offen offset:1024 lds
    buffer_load_dwordx4 v10, s[24:27], s57 offen offset:2048 lds
    v_mov_b32 v5, 4
    s_waitcnt vmcnt(3)
    ds_write_b32 v32, v5 offset:176
    s_add_u32 m0, s56, 3072
    s_add_u32 s57, s60, 1
    s_and_b32 s57, s57, 15
    s_add_u32 s57, s57, s61
    s_mul_i32 s57, s57, 88064
    buffer_load_dwordx4 v8, s[24:27], s57 offen offset:0 lds
    buffer_load_dwordx4 v9, s[24:27], s57 offen offset:1024 lds
    buffer_load_dwordx4 v10, s[24:27], s57 offen offset:2048 lds
lw_6:
    ds_read_b32 v3, v32 offset:192
    s_waitcnt lgkmcnt(0)
    v_readfirstlane_b32 s48, v3
    s_nop 0
    s_cmp_lt_u32 s48, 1
    s_cbranch_scc0 lwd_7
    s_sleep 1
    s_sub_u32 s47, s47, 1
    s_cbranch_scc0 lw_6
    s_mov_b32 s47, 0
lwd_7:
    s_waitcnt vmcnt(6)
    ds_write_b128 v33, v[188:191] offset:0
    ds_write_b128 v33, v[192:195] offset:1024
    ds_write_b128 v33, v[196:199] offset:2048
    ds_write_b128 v33, v[200:203] offset:3072
    ds_write_b128 v33, v[204:207] offset:4096
    ds_write_b128 v33, v[208:211] offset:5120
    ds_write_b128 v33, v[212:215] offset:6144
    ds_write_b128 v33, v[216:219] offset:7168
    ds_write_b128 v33, v[220:223] offset:8192
    ds_write_b128 v33, v[224:227] offset:9216
    ds_write_b128 v33, v[228:231] offset:10240
    ds_write_b128 v33, v[232:235] offset:11264
    ds_write_b128 v33, v[236:239] offset:12288
    ds_write_b128 v33, v[240:243] offset:13312
    ds_write_b128 v33, v[244:247] offset:14336
    ds_write_b128 v33, v[248:251] offset:15360
    v_mov_b32 v3, 1
    s_mov_b64 exec, 1
    ds_add_u32 v1, v3 offset:4
    s_mov_b64 exec, -1
    s_waitcnt lgkmcnt(0)
    s_add_u32 m0, s56, 6144
    s_add_u32 s57, s60, 2
    s_and_b32 s57, s57, 15
    s_add_u32 s57, s57, s61
    s_mul_i32 s57, s57, 88064
    buffer_load_dwordx4 v8, s[24:27], s57 offen offset:0 lds
    buffer_load_dwordx4 v9, s[24:27], s57 offen offset:1024 lds
    buffer_load_dwordx4 v10, s[24:27], s57 offen offset:2048 lds
    s_add_u32 m0, s56, 9216
    s_add_u32 s57, s60, 3
    s_and_b32 s57, s57, 15
    s_add_u32 s57, s57, s61
    s_mul_i32 s57, s57, 88064
    buffer_load_dwordx4 v8, s[24:27], s57 offen offset:0 lds
    buffer_load_dwordx4 v9, s[24:27], s57 offen offset:1024 lds
    buffer_load_dwordx4 v10, s[24:27], s57 offen offset:2048 lds
    ds_read_b32 v3, v1 offset:72
    s_waitcnt vmcnt(9)
    ds_read_b64_tr_b16 v[60:61], v11 offset:0
    ds_read_b64_tr_b16 v[62:63], v11 offset:1536
    ds_read_b64_tr_b16 v[64:65], v11 offset:32
    ds_read_b64_tr_b16 v[66:67], v11 offset:1568
    ds_read_b64_tr_b16 v[68:69], v11 offset:64
    ds_read_b64_tr_b16 v[70:71], v11 offset:1600
    s_waitcnt lgkmcnt(0)
    v_readfirstlane_b32 s62, v3
    s_add_u32 m0, s56, 0
    s_add_u32 s57, s60, 4
    s_and_b32 s57, s57, 15
    s_add_u32 s57, s57, s61
    s_mul_i32 s57, s57, 88064
    s_cmp_ge_u32 s62, 8
    s_cbranch_scc1 th_8
    s_waitcnt vmcnt(1)
th_8:
    buffer_load_dwordx4 v8, s[24:27], s57 offen offset:0 lds
    s_cmp_ge_u32 s62, 8
    s_cbranch_scc1 th_9
    s_waitcnt vmcnt(1)
th_9:
    buffer_load_dwordx4 v9, s[24:27], s57 offen offset:1024 lds
    s_cmp_ge_u32 s62, 8
    s_cbranch_scc1 th_10
    s_waitcnt vmcnt(1)
th_10:
    buffer_load_dwordx4 v10, s[24:27], s57 offen offset:2048 lds
    ds_read_b32 v3, v1 offset:72
    s_waitcnt vmcnt(9)
    ds_read_b64_tr_b16 v[72:73], v11 offset:3072
    ds_read_b64_tr_b16 v[74:75], v11 offset:4608
    ds_read_b64_tr_b16 v[76:77], v11 offset:3104
    ds_read_b64_tr_b16 v[78:79], v11 offset:4640
    ds_read_b64_tr_b16 v[80:81], v11 offset:3136
    ds_read_b64_tr_b16 v[82:83], v11 offset:4672
    s_waitcnt lgkmcnt(0)
    v_readfirstlane_b32 s62, v3
    s_add_u32 m0, s56, 3072
    s_add_u32 s57, s60, 5
    s_and_b32 s57, s57, 15
    s_add_u32 s57, s57, s61
    s_mul_i32 s57, s57, 88064
    s_cmp_ge_u32 s62, 8
    s_cbranch_scc1 th_11
    s_waitcnt vmcnt(1)
th_11:
    buffer_load_dwordx4 v8, s[24:27], s57 offen offset:0 lds
    s_cmp_ge_u32 s62, 8
    s_cbranch_scc1 th_12
    s_waitcnt vmcnt(1)
th_12:
    buffer_load_dwordx4 v9, s[24:27], s57 offen offset:1024 lds
    s_cmp_ge_u32 s62, 8
    s_cbranch_scc1 th_13
    s_waitcnt vmcnt(1)
th_13:
    buffer_load_dwordx4 v10, s[24:27], s57 offen offset:2048 lds
    ds_read_b32 v3, v1 offset:72
    s_waitcnt vmcnt(9)
    ds_read_b64_tr_b16 v[84:85], v11 offset:6144
    ds_read_b64_tr_b16 v[86:87], v11 offset:7680
    ds_read_b64_tr_b16 v[88:89], v11 offset:6176
    ds_read_b64_tr_b16 v[90:91], v11 offset:7712
    ds_read_b64_tr_b16 v[92:93], v11 offset:6208
    ds_read_b64_tr_b16 v[94:95], v11 offset:7744
    s_waitcnt lgkmcnt(0)
    v_readfirstlane_b32 s62, v3
    s_add_u32 m0, s56, 6144
    s_add_u32 s57, s60, 6
    s_and_b32 s57, s57, 15
    s_add_u32 s57, s57, s61
    s_mul_i32 s57, s57, 88064
    s_cmp_ge_u32 s62, 8
    s_cbranch_scc1 th_14
    s_waitcnt vmcnt(1)
th_14:
    buffer_load_dwordx4 v8, s[24:27], s57 offen offset:0 lds
    s_cmp_ge_u32 s62, 8
    s_cbranch_scc1 th_15
    s_waitcnt vmcnt(1)
th_15:
    buffer_load_dwordx4 v9, s[24:27], s57 offen offset:1024 lds
    s_cmp_ge_u32 s62, 8
    s_cbranch_scc1 th_16
    s_waitcnt vmcnt(1)
th_16:
    buffer_load_dwordx4 v10, s[24:27], s57 offen offset:2048 lds
    ds_read_b32 v3, v1 offset:72
    s_waitcnt vmcnt(9)
    ds_read_b64_tr_b16 v[96:97], v11 offset:9216
    ds_read_b64_tr_b16 v[98:99], v11 offset:10752
    ds_read_b64_tr_b16 v[100:101], v11 offset:9248
    ds_read_b64_tr_b16 v[102:103], v11 offset:10784
    ds_read_b64_tr_b16 v[104:105], v11 offset:9280
    ds_read_b64_tr_b16 v[106:107], v11 offset:10816
    s_waitcnt lgkmcnt(0)
    v_readfirstlane_b32 s62, v3
    s_add_u32 m0, s56, 9216
    s_add_u32 s57, s60, 7
    s_and_b32 s57, s57, 15
    s_add_u32 s57, s57, s61
    s_mul_i32 s57, s57, 88064
    s_cmp_ge_u32 s62, 8
    s_cbranch_scc1 th_17
    s_waitcnt vmcnt(1)
th_17:
    buffer_load_dwordx4 v8, s[24:27], s57 offen offset:0 lds
    s_cmp_ge_u32 s62, 8
    s_cbranch_scc1 th_18
    s_waitcnt vmcnt(1)
th_18:
    buffer_load_dwordx4 v9, s[24:27], s57 offen offset:1024 lds
    s_cmp_ge_u32 s62, 8
    s_cbranch_scc1 th_19
    s_waitcnt vmcnt(1)
th_19:
    buffer_load_dwordx4 v10, s[24:27], s57 offen offset:2048 lds
    ds_read_b32 v3, v1 offset:72
    s_waitcnt vmcnt(9)
    ds_read_b64_tr_b16 v[108:109], v11 offset:0
    ds_read_b64_tr_b16 v[110:111], v11 offset:1536
    ds_read_b64_tr_b16 v[112:113], v11 offset:32
    ds_read_b64_tr_b16 v[114:115], v11 offset:1568
    ds_read_b64_tr_b16 v[116:117], v11 offset:64
    ds_read_b64_tr_b16 v[118:119], v11 offset:1600
    s_waitcnt lgkmcnt(0)
    v_readfirstlane_b32 s62, v3
    s_add_u32 m0, s56, 0
    s_add_u32 s57, s60, 8
    s_and_b32 s57, s57, 15
    s_add_u32 s57, s57, s61
    s_mul_i32 s57, s57, 88064
    s_cmp_ge_u32 s62, 8
    s_cbranch_scc1 th_20
    s_waitcnt vmcnt(1)
th_20:
    buffer_load_dwordx4 v8, s[24:27], s57 offen offset:0 lds
    s_cmp_ge_u32 s62, 8
    s_cbranch_scc1 th_21
    s_waitcnt vmcnt(1)
th_21:
    buffer_load_dwordx4 v9, s[24:27], s57 offen offset:1024 lds
    s_cmp_ge_u32 s62, 8
    s_cbranch_scc1 th_22
    s_waitcnt vmcnt(1)
th_22:
    buffer_load_dwordx4 v10, s[24:27], s57 offen offset:2048 lds
    ds_read_b32 v3, v1 offset:72
    s_waitcnt vmcnt(9)
    ds_read_b64_tr_b16 v[120:121], v11 offset:3072
    ds_read_b64_tr_b16 v[122:123], v11 offset:4608
    ds_read_b64_tr_b16 v[124:125], v11 offset:3104
    ds_read_b64_tr_b16 v[126:127], v11 offset:4640
    ds_read_b64_tr_b16 v[128:129], v11 offset:3136
    ds_read_b64_tr_b16 v[130:131], v11 offset:4672
    s_waitcnt lgkmcnt(0)
    v_readfirstlane_b32 s62, v3
    s_add_u32 m0, s56, 3072
    s_add_u32 s57, s60, 9
    s_and_b32 s57, s57, 15
    s_add_u32 s57, s57, s61
    s_mul_i32 s57, s57, 88064
    s_cmp_ge_u32 s62, 8
    s_cbranch_scc1 th_23
    s_waitcnt vmcnt(1)
th_23:
    buffer_load_dwordx4 v8, s[24:27], s57 offen offset:0 lds
    s_cmp_ge_u32 s62, 8
    s_cbranch_scc1 th_24
    s_waitcnt vmcnt(1)
th_24:
    buffer_load_dwordx4 v9, s[24:27], s57 offen offset:1024 lds
    s_cmp_ge_u32 s62, 8
    s_cbranch_scc1 th_25
    s_waitcnt vmcnt(1)
th_25:
    buffer_load_dwordx4 v10, s[24:27], s57 offen offset:2048 lds
    ds_read_b32 v3, v1 offset:72
    s_waitcnt vmcnt(9)
    ds_read_b64_tr_b16 v[132:133], v11 offset:6144
    ds_read_b64_tr_b16 v[134:135], v11 offset:7680
    ds_read_b64_tr_b16 v[136:137], v11 offset:6176
    ds_read_b64_tr_b16 v[138:139], v11 offset:7712
    ds_read_b64_tr_b16 v[140:141], v11 offset:6208
    ds_read_b64_tr_b16 v[142:143], v11 offset:7744
    s_waitcnt lgkmcnt(0)
    v_readfirstlane_b32 s62, v3
    s_add_u32 m0, s56, 6144
    s_add_u32 s57, s60, 10
    s_and_b32 s57, s57, 15
    s_add_u32 s57, s57, s61
    s_mul_i32 s57, s57, 88064
    s_cmp_ge_u32 s62, 8
    s_cbranch_scc1 th_26
    s_waitcnt vmcnt(1)
th_26:
    buffer_load_dwordx4 v8, s[24:27], s57 offen offset:0 lds
    s_cmp_ge_u32 s62, 8
    s_cbranch_scc1 th_27
    s_waitcnt vmcnt(1)
th_27:
    buffer_load_dwordx4 v9, s[24:27], s57 offen offset:1024 lds
    s_cmp_ge_u32 s62, 8
    s_cbranch_scc1 th_28
    s_waitcnt vmcnt(1)
th_28:
    buffer_load_dwordx4 v10, s[24:27], s57 offen offset:2048 lds
    ds_read_b32 v3, v1 offset:72
    s_waitcnt vmcnt(9)
    ds_read_b64_tr_b16 v[144:145], v11 offset:9216
    ds_read_b64_tr_b16 v[146:147], v11 offset:10752
    ds_read_b64_tr_b16 v[148:149], v11 offset:9248
    ds_read_b64_tr_b16 v[150:151], v11 offset:10784
    ds_read_b64_tr_b16 v[152:153], v11 offset:9280
    ds_read_b64_tr_b16 v[154:155], v11 offset:10816
    s_waitcnt lgkmcnt(0)
    v_readfirstlane_b32 s62, v3
    s_add_u32 m0, s56, 9216
    s_add_u32 s57, s60, 11
    s_and_b32 s57, s57, 15
    s_add_u32 s57, s57, s61
    s_mul_i32 s57, s57, 88064
    s_cmp_ge_u32 s62, 8
    s_cbranch_scc1 th_29
    s_waitcnt vmcnt(1)
th_29:
    buffer_load_dwordx4 v8, s[24:27], s57 offen offset:0 lds
    s_cmp_ge_u32 s62, 8
    s_cbranch_scc1 th_30
    s_waitcnt vmcnt(1)
th_30:
    buffer_load_dwordx4 v9, s[24:27], s57 offen offset:1024 lds
    s_cmp_ge_u32 s62, 8
    s_cbranch_scc1 th_31
    s_waitcnt vmcnt(1)
th_31:
    buffer_load_dwordx4 v10, s[24:27], s57 offen offset:2048 lds
    ds_read_b32 v3, v1 offset:72
    s_waitcnt vmcnt(9)
    ds_read_b64_tr_b16 v[156:157], v11 offset:0
    ds_read_b64_tr_b16 v[158:159], v11 offset:1536
    ds_read_b64_tr_b16 v[160:161], v11 offset:32
    ds_read_b64_tr_b16 v[162:163], v11 offset:1568
    ds_read_b64_tr_b16 v[164:165], v11 offset:64
    ds_read_b64_tr_b16 v[166:167], v11 offset:1600
    s_waitcnt lgkmcnt(0)
    v_readfirstlane_b32 s62, v3
    s_add_u32 m0, s56, 0
    s_add_u32 s57, s60, 12
    s_and_b32 s57, s57, 15
    s_add_u32 s57, s57, s61
    s_mul_i32 s57, s57, 88064
    s_cmp_ge_u32 s62, 8
    s_cbranch_scc1 th_32
    s_waitcnt vmcnt(1)
th_32:
    buffer_load_dwordx4 v8, s[24:27], s57 offen offset:0 lds
    s_cmp_ge_u32 s62, 8
    s_cbranch_scc1 th_33
    s_waitcnt vmcnt(1)
th_33:
    buffer_load_dwordx4 v9, s[24:27], s57 offen offset:1024 lds
    s_cmp_ge_u32 s62, 8
    s_cbranch_scc1 th_34
    s_waitcnt vmcnt(1)
th_34:
    buffer_load_dwordx4 v10, s[24:27], s57 offen offset:2048 lds
    ds_read_b32 v3, v1 offset:72
    s_waitcnt vmcnt(9)
    ds_read_b64_tr_b16 v[168:169], v11 offset:3072
    ds_read_b64_tr_b16 v[170:171], v11 offset:4608
    ds_read_b64_tr_b16 v[172:173], v11 offset:3104
    ds_read_b64_tr_b16 v[174:175], v11 offset:4640
    ds_read_b64_tr_b16 v[176:177], v11 offset:3136
    ds_read_b64_tr_b16 v[178:179], v11 offset:4672
    s_waitcnt lgkmcnt(0)
    v_readfirstlane_b32 s62, v3
    s_add_u32 m0, s56, 3072
    s_add_u32 s57, s60, 13
    s_and_b32 s57, s57, 15
    s_add_u32 s57, s57, s61
    s_mul_i32 s57, s57, 88064
    s_cmp_ge_u32 s62, 8
    s_cbranch_scc1 th_35
    s_waitcnt vmcnt(1)
th_35:
    buffer_load_dwordx4 v8, s[24:27], s57 offen offset:0 lds
    s_cmp_ge_u32 s62, 8
    s_cbranch_scc1 th_36
    s_waitcnt vmcnt(1)
th_36:
    buffer_load_dwordx4 v9, s[24:27], s57 offen offset:1024 lds
    s_cmp_ge_u32 s62, 8
    s_cbranch_scc1 th_37
    s_waitcnt vmcnt(1)
th_37:
    buffer_load_dwordx4 v10, s[24:27], s57 offen offset:2048 lds
    ds_read_b32 v3, v1 offset:72
    s_waitcnt vmcnt(9)
    ds_read_b64_tr_b16 v[180:181], v11 offset:6144
    ds_read_b64_tr_b16 v[182:183], v11 offset:7680
    ds_read_b64_tr_b16 v[184:185], v11 offset:6176
    ds_read_b64_tr_b16 v[186:187], v11 offset:7712
    ds_read_b64_tr_b16 v[188:189], v11 offset:6208
    ds_read_b64_tr_b16 v[190:191], v11 offset:7744
    s_waitcnt lgkmcnt(0)
    v_readfirstlane_b32 s62, v3
    s_add_u32 m0, s56, 6144
    s_add_u32 s57, s60, 14
    s_and_b32 s57, s57, 15
    s_add_u32 s57, s57, s61
    s_mul_i32 s57, s57, 88064
    s_cmp_ge_u32 s62, 8
    s_cbranch_scc1 th_38
    s_waitcnt vmcnt(1)
th_38:
    buffer_load_dwordx4 v8, s[24:27], s57 offen offset:0 lds
    s_cmp_ge_u32 s62, 8
    s_cbranch_scc1 th_39
    s_waitcnt vmcnt(1)
th_39:
    buffer_load_dwordx4 v9, s[24:27], s57 offen offset:1024 lds
    s_cmp_ge_u32 s62, 8
    s_cbranch_scc1 th_40
    s_waitcnt vmcnt(1)
th_40:
    buffer_load_dwordx4 v10, s[24:27], s57 offen offset:2048 lds
    ds_read_b32 v3, v1 offset:72
    s_waitcnt vmcnt(9)
    ds_read_b64_tr_b16 v[192:193], v11 offset:9216
    ds_read_b64_tr_b16 v[194:195], v11 offset:10752
    ds_read_b64_tr_b16 v[196:197], v11 offset:9248
    ds_read_b64_tr_b16 v[198:199], v11 offset:10784
    ds_read_b64_tr_b16 v[200:201], v11 offset:9280
    ds_read_b64_tr_b16 v[202:203], v11 offset:10816
    s_waitcnt lgkmcnt(0)
    v_readfirstlane_b32 s62, v3
    s_add_u32 m0, s56, 9216
    s_add_u32 s57, s60, 15
    s_and_b32 s57, s57, 15
    s_add_u32 s57, s57, s61
    s_mul_i32 s57, s57, 88064
    s_cmp_ge_u32 s62, 8
    s_cbranch_scc1 th_41
    s_waitcnt vmcnt(1)
th_41:
    buffer_load_dwordx4 v8, s[24:27], s57 offen offset:0 lds
    s_cmp_ge_u32 s62, 8
    s_cbranch_scc1 th_42
    s_waitcnt vmcnt(1)
th_42:
    buffer_load_dwordx4 v9, s[24:27], s57 offen offset:1024 lds
    s_cmp_ge_u32 s62, 8
    s_cbranch_scc1 th_43
    s_waitcnt vmcnt(1)
th_43:
    buffer_load_dwordx4 v10, s[24:27], s57 offen offset:2048 lds
    v_bfe_u32 v10, v0, 5, 1
    v_lshlrev_b32 v3, 4, v10
    s_mul_i32 s59, s45, 96
    s_lshl_b32 s58, s7, 5
    s_add_u32 s59, s59, s58
    buffer_load_dwordx4 v[6:9], v3, s[32:35], s59 offen
    v_lshlrev_b32 v10, 9, v10
    v_bfe_u32 v3, v0, 4, 1
    v_lshl_add_u32 v10, v3, 10, v10
    v_and_b32 v3, 15, v0
    v_lshl_add_u32 v10, v3, 4, v10
    s_mul_i32 s63, s45, 3
    s_add_u32 s63, s63, s7
    s_lshl_b32 s63, s63, 14
    s_lshl_b32 s58, s44, 11
    s_add_u32 s63, s63, s58
    s_add_u32 s63, s63, 8389632
    s_lshl_b32 s68, s44, 9
    s_lshr_b32 s58, s45, 3
    s_lshl_b32 s58, s58, 7
    s_add_u32 s68, s68, s58
    s_and_b32 s58, s45, 7
    s_lshl_b32 s58, s58, 2
    s_add_u32 s68, s68, s58
    s_add_u32 s68, s68, 10715136
    s_lshl_b32 s58, s7, 11
    v_add_u32 v5, s58, v2
    s_add_u32 s58, s58, 114432
    v_add_u32 v10, s58, v10
    v_add_u32 v252, s7, v1
    v_mov_b32 v253, 0x80
    v_add_u32 v254, s56, v2
    v_and_b32 v4, 7, v0
    v_lshlrev_b32 v4, 2, v4
    s_lshl_b32 s57, s44, 9
    s_lshl_b32 s58, s7, 7
    s_add_u32 s57, s57, s58
    s_add_u32 s57, s57, 10551296
    s_and_b32 s58, s2, 7
    s_lshl_b32 s58, s58, 12
    s_add_u32 s57, s57, s58
    s_lshl_b32 s62, s44, 12
    s_add_u32 s62, s62, 6291456
    ds_write_b8 v252, v253 offset:120
    s_waitcnt vmcnt(0)
lw_44:
    ds_read_b32 v3, v1 offset:72
    s_waitcnt lgkmcnt(0)
    v_readfirstlane_b32 s48, v3
    s_nop 0
    s_cmp_lt_u32 s48, 8
    s_cbranch_scc0 lwd_45
    s_sleep 1
    s_sub_u32 s47, s47, 1
    s_cbranch_scc0 lw_44
    s_mov_b32 s47, 0
lwd_45:
pl_46:
    buffer_load_dword v3, v4, s[8:11], s57 offen sc1
    s_sub_u32 s47, s47, 1
    s_cselect_b64 s[98:99], -1, 0
    s_andn2_b32 s47, s47, s98
    s_waitcnt vmcnt(0)
    v_cmp_ne_u32 vcc, s4, v3
    s_nop 0
    s_andn2_b64 vcc, vcc, s[98:99]
    s_cbranch_scc1 pl_46
    s_setprio 2
    s_add_u32 s57, s60, 0
    s_and_b32 s57, s57, 15
    s_add_u32 s57, s57, s61
    s_mul_i32 s57, s57, 32768
    s_add_u32 s57, s57, s62
    buffer_load_dwordx4 v[204:207], v2, s[8:11], s57 offen offset:0 sc1
    buffer_load_dwordx4 v[208:211], v2, s[8:11], s57 offen offset:1024 sc1
    s_add_u32 s57, s60, 1
    s_and_b32 s57, s57, 15
    s_add_u32 s57, s57, s61
    s_mul_i32 s57, s57, 32768
    s_add_u32 s57, s57, s62
    buffer_load_dwordx4 v[212:215], v2, s[8:11], s57 offen offset:0 sc1
    buffer_load_dwordx4 v[216:219], v2, s[8:11], s57 offen offset:1024 sc1
    s_add_u32 s57, s60, 2
    s_and_b32 s57, s57, 15
    s_add_u32 s57, s57, s61
    s_mul_i32 s57, s57, 32768
    s_add_u32 s57, s57, s62
    buffer_load_dwordx4 v[220:223], v2, s[8:11], s57 offen offset:0 sc1
    buffer_load_dwordx4 v[224:227], v2, s[8:11], s57 offen offset:1024 sc1
    s_add_u32 s57, s60, 3
    s_and_b32 s57, s57, 15
    s_add_u32 s57, s57, s61
    s_mul_i32 s57, s57, 32768
    s_add_u32 s57, s57, s62
    buffer_load_dwordx4 v[228:231], v2, s[8:11], s57 offen offset:0 sc1
    buffer_load_dwordx4 v[232:235], v2, s[8:11], s57 offen offset:1024 sc1
    s_add_u32 s57, s60, 4
    s_and_b32 s57, s57, 15
    s_add_u32 s57, s57, s61
    s_mul_i32 s57, s57, 32768
    s_add_u32 s57, s57, s62
    buffer_load_dwordx4 v[236:239], v2, s[8:11], s57 offen offset:0 sc1
    buffer_load_dwordx4 v[240:243], v2, s[8:11], s57 offen offset:1024 sc1
    s_add_u32 s57, s60, 5
    s_and_b32 s57, s57, 15
    s_add_u32 s57, s57, s61
    s_mul_i32 s57, s57, 32768
    s_add_u32 s57, s57, s62
    buffer_load_dwordx4 v[244:247], v2, s[8:11], s57 offen offset:0 sc1
    buffer_load_dwordx4 v[248:251], v2, s[8:11], s57 offen offset:1024 sc1
    s_waitcnt vmcnt(10)
    v_mfma_f32_16x16x32_bf16 v[12:15], v[60:63], v[204:207], 0
    s_add_u32 s57, s60, 6
    s_and_b32 s57, s57, 15
    s_add_u32 s57, s57, s61
    v_mfma_f32_16x16x32_bf16 v[16:19], v[64:67], v[204:207], 0
    s_mul_i32 s57, s57, 32768
    s_add_u32 s57, s57, s62
    v_mfma_f32_16x16x32_bf16 v[20:23], v[68:71], v[204:207], 0
    buffer_load_dwordx4 v[204:207], v2, s[8:11], s57 offen offset:0 sc1
    v_mfma_f32_16x16x32_bf16 v[24:27], v[60:63], v[208:211], 0
    v_mfma_f32_16x16x32_bf16 v[28:31], v[64:67], v[208:211], 0
    v_mfma_f32_16x16x32_bf16 v[32:35], v[68:71], v[208:211], 0
    buffer_load_dwordx4 v[208:211], v2, s[8:11], s57 offen offset:1024 sc1
    s_waitcnt vmcnt(10)
    v_mfma_f32_16x16x32_bf16 v[12:15], v[72:75], v[212:215], v[12:15]
    s_add_u32 s57, s60, 7
    s_and_b32 s57, s57, 15
    s_add_u32 s57, s57, s61
    v_mfma_f32_16x16x32_bf16 v[16:19], v[76:79], v[212:215], v[16:19]
    s_mul_i32 s57, s57, 32768
    s_add_u32 s57, s57, s62
    v_mfma_f32_16x16x32_bf16 v[20:23], v[80:83], v[212:215], v[20:23]
    buffer_load_dwordx4 v[212:215], v2, s[8:11], s57 offen offset:0 sc1
    v_mfma_f32_16x16x32_bf16 v[24:27], v[72:75], v[216:219], v[24:27]
    v_mfma_f32_16x16x32_bf16 v[28:31], v[76:79], v[216:219], v[28:31]
    v_mfma_f32_16x16x32_bf16 v[32:35], v[80:83], v[216:219], v[32:35]
    buffer_load_dwordx4 v[216:219], v2, s[8:11], s57 offen offset:1024 sc1
    s_waitcnt vmcnt(10)
    v_mfma_f32_16x16x32_bf16 v[12:15], v[84:87], v[220:223], v[12:15]
    s_add_u32 s57, s60, 8
    s_and_b32 s57, s57, 15
    s_add_u32 s57, s57, s61
    v_mfma_f32_16x16x32_bf16 v[16:19], v[88:91], v[220:223], v[16:19]
    s_mul_i32 s57, s57, 32768
    s_add_u32 s57, s57, s62
    v_mfma_f32_16x16x32_bf16 v[20:23], v[92:95], v[220:223], v[20:23]
    buffer_load_dwordx4 v[220:223], v2, s[8:11], s57 offen offset:0 sc1
    v_mfma_f32_16x16x32_bf16 v[24:27], v[84:87], v[224:227], v[24:27]
    v_mfma_f32_16x16x32_bf16 v[28:31], v[88:91], v[224:227], v[28:31]
    v_mfma_f32_16x16x32_bf16 v[32:35], v[92:95], v[224:227], v[32:35]
    buffer_load_dwordx4 v[224:227], v2, s[8:11], s57 offen offset:1024 sc1
    s_waitcnt vmcnt(10)
    v_mfma_f32_16x16x32_bf16 v[12:15], v[96:99], v[228:231], v[12:15]
    s_add_u32 s57, s60, 9
    s_and_b32 s57, s57, 15
    s_add_u32 s57, s57, s61
    v_mfma_f32_16x16x32_bf16 v[16:19], v[100:103], v[228:231], v[16:19]
    s_mul_i32 s57, s57, 32768
    s_add_u32 s57, s57, s62
    v_mfma_f32_16x16x32_bf16 v[20:23], v[104:107], v[228:231], v[20:23]
    buffer_load_dwordx4 v[228:231], v2, s[8:11], s57 offen offset:0 sc1
    v_mfma_f32_16x16x32_bf16 v[24:27], v[96:99], v[232:235], v[24:27]
    v_mfma_f32_16x16x32_bf16 v[28:31], v[100:103], v[232:235], v[28:31]
    v_mfma_f32_16x16x32_bf16 v[32:35], v[104:107], v[232:235], v[32:35]
    buffer_load_dwordx4 v[232:235], v2, s[8:11], s57 offen offset:1024 sc1
    s_waitcnt vmcnt(10)
    v_mfma_f32_16x16x32_bf16 v[12:15], v[108:111], v[236:239], v[12:15]
    s_add_u32 s57, s60, 10
    s_and_b32 s57, s57, 15
    s_add_u32 s57, s57, s61
    v_mfma_f32_16x16x32_bf16 v[16:19], v[112:115], v[236:239], v[16:19]
    s_mul_i32 s57, s57, 32768
    s_add_u32 s57, s57, s62
    v_mfma_f32_16x16x32_bf16 v[20:23], v[116:119], v[236:239], v[20:23]
    buffer_load_dwordx4 v[236:239], v2, s[8:11], s57 offen offset:0 sc1
    v_mfma_f32_16x16x32_bf16 v[24:27], v[108:111], v[240:243], v[24:27]
    v_mfma_f32_16x16x32_bf16 v[28:31], v[112:115], v[240:243], v[28:31]
    v_mfma_f32_16x16x32_bf16 v[32:35], v[116:119], v[240:243], v[32:35]
    buffer_load_dwordx4 v[240:243], v2, s[8:11], s57 offen offset:1024 sc1
    s_waitcnt vmcnt(10)
    v_mfma_f32_16x16x32_bf16 v[12:15], v[120:123], v[244:247], v[12:15]
    s_add_u32 s57, s60, 11
    s_and_b32 s57, s57, 15
    s_add_u32 s57, s57, s61
    v_mfma_f32_16x16x32_bf16 v[16:19], v[124:127], v[244:247], v[16:19]
    s_mul_i32 s57, s57, 32768
    s_add_u32 s57, s57, s62
    v_mfma_f32_16x16x32_bf16 v[20:23], v[128:131], v[244:247], v[20:23]
    buffer_load_dwordx4 v[244:247], v2, s[8:11], s57 offen offset:0 sc1
    v_mfma_f32_16x16x32_bf16 v[24:27], v[120:123], v[248:251], v[24:27]
    v_mfma_f32_16x16x32_bf16 v[28:31], v[124:127], v[248:251], v[28:31]
    v_mfma_f32_16x16x32_bf16 v[32:35], v[128:131], v[248:251], v[32:35]
    buffer_load_dwordx4 v[248:251], v2, s[8:11], s57 offen offset:1024 sc1
    s_waitcnt vmcnt(10)
    v_mfma_f32_16x16x32_bf16 v[12:15], v[132:135], v[204:207], v[12:15]
    s_add_u32 s57, s60, 12
    s_and_b32 s57, s57, 15
    s_add_u32 s57, s57, s61
    v_mfma_f32_16x16x32_bf16 v[16:19], v[136:139], v[204:207], v[16:19]
    s_mul_i32 s57, s57, 32768
    s_add_u32 s57, s57, s62
    v_mfma_f32_16x16x32_bf16 v[20:23], v[140:143], v[204:207], v[20:23]
    buffer_load_dwordx4 v[204:207], v2, s[8:11], s57 offen offset:0 sc1
    v_mfma_f32_16x16x32_bf16 v[24:27], v[132:135], v[208:211], v[24:27]
    v_mfma_f32_16x16x32_bf16 v[28:31], v[136:139], v[208:211], v[28:31]
    v_mfma_f32_16x16x32_bf16 v[32:35], v[140:143], v[208:211], v[32:35]
    buffer_load_dwordx4 v[208:211], v2, s[8:11], s57 offen offset:1024 sc1
    s_waitcnt vmcnt(10)
    v_mfma_f32_16x16x32_bf16 v[12:15], v[144:147], v[212:215], v[12:15]
    s_add_u32 s57, s60, 13
    s_and_b32 s57, s57, 15
    s_add_u32 s57, s57, s61
    v_mfma_f32_16x16x32_bf16 v[16:19], v[148:151], v[212:215], v[16:19]
    s_mul_i32 s57, s57, 32768
    s_add_u32 s57, s57, s62
    v_mfma_f32_16x16x32_bf16 v[20:23], v[152:155], v[212:215], v[20:23]
    buffer_load_dwordx4 v[212:215], v2, s[8:11], s57 offen offset:0 sc1
    v_mfma_f32_16x16x32_bf16 v[24:27], v[144:147], v[216:219], v[24:27]
    v_mfma_f32_16x16x32_bf16 v[28:31], v[148:151], v[216:219], v[28:31]
    v_mfma_f32_16x16x32_bf16 v[32:35], v[152:155], v[216:219], v[32:35]
    buffer_load_dwordx4 v[216:219], v2, s[8:11], s57 offen offset:1024 sc1
    s_waitcnt vmcnt(10)
    v_mfma_f32_16x16x32_bf16 v[12:15], v[156:159], v[220:223], v[12:15]
    s_add_u32 s57, s60, 14
    s_and_b32 s57, s57, 15
    s_add_u32 s57, s57, s61
    v_mfma_f32_16x16x32_bf16 v[16:19], v[160:163], v[220:223], v[16:19]
    s_mul_i32 s57, s57, 32768
    s_add_u32 s57, s57, s62
    v_mfma_f32_16x16x32_bf16 v[20:23], v[164:167], v[220:223], v[20:23]
    buffer_load_dwordx4 v[220:223], v2, s[8:11], s57 offen offset:0 sc1
    v_mfma_f32_16x16x32_bf16 v[24:27], v[156:159], v[224:227], v[24:27]
    v_mfma_f32_16x16x32_bf16 v[28:31], v[160:163], v[224:227], v[28:31]
    v_mfma_f32_16x16x32_bf16 v[32:35], v[164:167], v[224:227], v[32:35]
    buffer_load_dwordx4 v[224:227], v2, s[8:11], s57 offen offset:1024 sc1
    s_waitcnt vmcnt(10)
    v_mfma_f32_16x16x32_bf16 v[12:15], v[168:171], v[228:231], v[12:15]
    s_add_u32 s57, s60, 15
    s_and_b32 s57, s57, 15
    s_add_u32 s57, s57, s61
    v_mfma_f32_16x16x32_bf16 v[16:19], v[172:175], v[228:231], v[16:19]
    s_mul_i32 s57, s57, 32768
    s_add_u32 s57, s57, s62
    v_mfma_f32_16x16x32_bf16 v[20:23], v[176:179], v[228:231], v[20:23]
    buffer_load_dwordx4 v[228:231], v2, s[8:11], s57 offen offset:0 sc1
    v_mfma_f32_16x16x32_bf16 v[24:27], v[168:171], v[232:235], v[24:27]
    v_mfma_f32_16x16x32_bf16 v[28:31], v[172:175], v[232:235], v[28:31]
    v_mfma_f32_16x16x32_bf16 v[32:35], v[176:179], v[232:235], v[32:35]
    buffer_load_dwordx4 v[232:235], v2, s[8:11], s57 offen offset:1024 sc1
    s_waitcnt vmcnt(10)
    v_mfma_f32_16x16x32_bf16 v[12:15], v[180:183], v[236:239], v[12:15]
    s_add_u32 s57, s60, 0
    s_and_b32 s57, s57, 15
    s_add_u32 s57, s57, s61
    v_mfma_f32_16x16x32_bf16 v[16:19], v[184:187], v[236:239], v[16:19]
    s_mul_i32 s57, s57, 32768
    s_add_u32 s57, s57, s62
    v_mfma_f32_16x16x32_bf16 v[20:23], v[188:191], v[236:239], v[20:23]
    buffer_load_dwordx4 v[236:239], v2, s[8:11], s57 offen offset:2048 sc1
    v_mfma_f32_16x16x32_bf16 v[24:27], v[180:183], v[240:243], v[24:27]
    v_mfma_f32_16x16x32_bf16 v[28:31], v[184:187], v[240:243], v[28:31]
    v_mfma_f32_16x16x32_bf16 v[32:35], v[188:191], v[240:243], v[32:35]
    buffer_load_dwordx4 v[240:243], v2, s[8:11], s57 offen offset:3072 sc1
    ds_read_b64_tr_b16 v[36:37], v11 offset:0
    ds_read_b64_tr_b16 v[38:39], v11 offset:1536
    ds_read_b64_tr_b16 v[40:41], v11 offset:32
    ds_read_b64_tr_b16 v[42:43], v11 offset:1568
    ds_read_b64_tr_b16 v[44:45], v11 offset:64
    ds_read_b64_tr_b16 v[46:47], v11 offset:1600
    s_waitcnt vmcnt(10)
    v_mfma_f32_16x16x32_bf16 v[12:15], v[192:195], v[244:247], v[12:15]
    s_add_u32 s57, s60, 1
    s_and_b32 s57, s57, 15
    s_add_u32 s57, s57, s61
    v_mfma_f32_16x16x32_bf16 v[16:19], v[196:199], v[244:247], v[16:19]
    s_mul_i32 s57, s57, 32768
    s_add_u32 s57, s57, s62
    v_mfma_f32_16x16x32_bf16 v[20:23], v[200:203], v[244:247], v[20:23]
    buffer_load_dwordx4 v[244:247], v2, s[8:11], s57 offen offset:2048 sc1
    v_mfma_f32_16x16x32_bf16 v[24:27], v[192:195], v[248:251], v[24:27]
    v_mfma_f32_16x16x32_bf16 v[28:31], v[196:199], v[248:251], v[28:31]
    v_mfma_f32_16x16x32_bf16 v[32:35], v[200:203], v[248:251], v[32:35]
    buffer_load_dwordx4 v[248:251], v2, s[8:11], s57 offen offset:3072 sc1
    ds_read_b64_tr_b16 v[48:49], v11 offset:3072
    ds_read_b64_tr_b16 v[50:51], v11 offset:4608
    ds_read_b64_tr_b16 v[52:53], v11 offset:3104
    ds_read_b64_tr_b16 v[54:55], v11 offset:4640
    ds_read_b64_tr_b16 v[56:57], v11 offset:3136
    ds_read_b64_tr_b16 v[58:59], v11 offset:4672
    s_waitcnt vmcnt(10) lgkmcnt(6)
    v_mfma_f32_16x16x32_bf16 v[12:15], v[36:39], v[204:207], v[12:15]
    s_add_u32 s57, s60, 2
    s_and_b32 s57, s57, 15
    s_add_u32 s57, s57, s61
    v_mfma_f32_16x16x32_bf16 v[16:19], v[40:43], v[204:207], v[16:19]
    s_mul_i32 s57, s57, 32768
    s_add_u32 s57, s57, s62
    v_mfma_f32_16x16x32_bf16 v[20:23], v[44:47], v[204:207], v[20:23]
    buffer_load_dwordx4 v[204:207], v2, s[8:11], s57 offen offset:2048 sc1
    v_mfma_f32_16x16x32_bf16 v[24:27], v[36:39], v[208:211], v[24:27]
    v_mfma_f32_16x16x32_bf16 v[28:31], v[40:43], v[208:211], v[28:31]
    v_mfma_f32_16x16x32_bf16 v[32:35], v[44:47], v[208:211], v[32:35]
    buffer_load_dwordx4 v[208:211], v2, s[8:11], s57 offen offset:3072 sc1
    ds_read_b64_tr_b16 v[36:37], v11 offset:6144
    ds_read_b64_tr_b16 v[38:39], v11 offset:7680
    ds_read_b64_tr_b16 v[40:41], v11 offset:6176
    ds_read_b64_tr_b16 v[42:43], v11 offset:7712
    ds_read_b64_tr_b16 v[44:45], v11 offset:6208
    ds_read_b64_tr_b16 v[46:47], v11 offset:7744
    s_waitcnt vmcnt(10) lgkmcnt(6)
    v_mfma_f32_16x16x32_bf16 v[12:15], v[48:51], v[212:215], v[12:15]
    s_add_u32 s57, s60, 3
    s_and_b32 s57, s57, 15
    s_add_u32 s57, s57, s61
    v_mfma_f32_16x16x32_bf16 v[16:19], v[52:55], v[212:215], v[16:19]
    s_mul_i32 s57, s57, 32768
    s_add_u32 s57, s57, s62
    v_mfma_f32_16x16x32_bf16 v[20:23], v[56:59], v[212:215], v[20:23]
    buffer_load_dwordx4 v[212:215], v2, s[8:11], s57 offen offset:2048 sc1
    v_mfma_f32_16x16x32_bf16 v[24:27], v[48:51], v[216:219], v[24:27]
    v_mfma_f32_16x16x32_bf16 v[28:31], v[52:55], v[216:219], v[28:31]
    v_mfma_f32_16x16x32_bf16 v[32:35], v[56:59], v[216:219], v[32:35]
    buffer_load_dwordx4 v[216:219], v2, s[8:11], s57 offen offset:3072 sc1
    ds_read_b64_tr_b16 v[48:49], v11 offset:9216
    ds_read_b64_tr_b16 v[50:51], v11 offset:10752
    ds_read_b64_tr_b16 v[52:53], v11 offset:9248
    ds_read_b64_tr_b16 v[54:55], v11 offset:10784
    ds_read_b64_tr_b16 v[56:57], v11 offset:9280
    ds_read_b64_tr_b16 v[58:59], v11 offset:10816
    s_waitcnt vmcnt(10) lgkmcnt(6)
    v_mfma_f32_16x16x32_bf16 v[12:15], v[36:39], v[220:223], v[12:15]
    s_add_u32 s57, s60, 4
    s_and_b32 s57, s57, 15
    s_add_u32 s57, s57, s61
    v_mfma_f32_16x16x32_bf16 v[16:19], v[40:43], v[220:223], v[16:19]
    s_mul_i32 s57, s57, 32768
    s_add_u32 s57, s57, s62
    v_mfma_f32_16x16x32_bf16 v[20:23], v[44:47], v[220:223], v[20:23]
    buffer_load_dwordx4 v[220:223], v2, s[8:11], s57 offen offset:2048 sc1
    v_mfma_f32_16x16x32_bf16 v[24:27], v[36:39], v[224:227], v[24:27]
    v_mfma_f32_16x16x32_bf16 v[28:31], v[40:43], v[224:227], v[28:31]
    v_mfma_f32_16x16x32_bf16 v[32:35], v[44:47], v[224:227], v[32:35]
    buffer_load_dwordx4 v[224:227], v2, s[8:11], s57 offen offset:3072 sc1
    s_waitcnt vmcnt(10) lgkmcnt(0)
    v_mfma_f32_16x16x32_bf16 v[12:15], v[48:51], v[228:231], v[12:15]
    s_add_u32 s57, s60, 5
    s_and_b32 s57, s57, 15
    s_add_u32 s57, s57, s61
    v_mfma_f32_16x16x32_bf16 v[16:19], v[52:55], v[228:231], v[16:19]
    s_mul_i32 s57, s57, 32768
    s_add_u32 s57, s57, s62
    v_mfma_f32_16x16x32_bf16 v[20:23], v[56:59], v[228:231], v[20:23]
    buffer_load_dwordx4 v[228:231], v2, s[8:11], s57 offen offset:2048 sc1
    v_mfma_f32_16x16x32_bf16 v[24:27], v[48:51], v[232:235], v[24:27]
    v_mfma_f32_16x16x32_bf16 v[28:31], v[52:55], v[232:235], v[28:31]
    v_mfma_f32_16x16x32_bf16 v[32:35], v[56:59], v[232:235], v[32:35]
    buffer_load_dwordx4 v[232:235], v2, s[8:11], s57 offen offset:3072 sc1
    ds_write_b128 v5, v[12:15] offset:12288
    s_nop 3
    ds_write_b128 v5, v[24:27] offset:13312
    ds_write_b128 v5, v[16:19] offset:34816
    ds_write_b128 v5, v[28:31] offset:35840
    ds_write_b128 v5, v[20:23] offset:57344
    ds_write_b128 v5, v[32:35] offset:58368
    ds_write_b8 v252, v253 offset:36
    s_waitcnt vmcnt(10) lgkmcnt(0)
    v_mfma_f32_16x16x32_bf16 v[12:15], v[60:63], v[236:239], 0
    s_add_u32 s57, s60, 6
    s_and_b32 s57, s57, 15
    s_add_u32 s57, s57, s61
    v_mfma_f32_16x16x32_bf16 v[16:19], v[64:67], v[236:239], 0
    s_mul_i32 s57, s57, 32768
    s_add_u32 s57, s57, s62
    v_mfma_f32_16x16x32_bf16 v[20:23], v[68:71], v[236:239], 0
    buffer_load_dwordx4 v[236:239], v2, s[8:11], s57 offen offset:2048 sc1
    v_mfma_f32_16x16x32_bf16 v[24:27], v[60:63], v[240:243], 0
    v_mfma_f32_16x16x32_bf16 v[28:31], v[64:67], v[240:243], 0
    v_mfma_f32_16x16x32_bf16 v[32:35], v[68:71], v[240:243], 0
    buffer_load_dwordx4 v[240:243], v2, s[8:11], s57 offen offset:3072 sc1
    s_waitcnt vmcnt(10)
    v_mfma_f32_16x16x32_bf16 v[12:15], v[72:75], v[244:247], v[12:15]
    s_add_u32 s57, s60, 7
    s_and_b32 s57, s57, 15
    s_add_u32 s57, s57, s61
    v_mfma_f32_16x16x32_bf16 v[16:19], v[76:79], v[244:247], v[16:19]
    s_mul_i32 s57, s57, 32768
    s_add_u32 s57, s57, s62
    v_mfma_f32_16x16x32_bf16 v[20:23], v[80:83], v[244:247], v[20:23]
    buffer_load_dwordx4 v[244:247], v2, s[8:11], s57 offen offset:2048 sc1
    v_mfma_f32_16x16x32_bf16 v[24:27], v[72:75], v[248:251], v[24:27]
    v_mfma_f32_16x16x32_bf16 v[28:31], v[76:79], v[248:251], v[28:31]
    v_mfma_f32_16x16x32_bf16 v[32:35], v[80:83], v[248:251], v[32:35]
    buffer_load_dwordx4 v[248:251], v2, s[8:11], s57 offen offset:3072 sc1
    s_waitcnt vmcnt(10)
    v_mfma_f32_16x16x32_bf16 v[12:15], v[84:87], v[204:207], v[12:15]
    s_add_u32 s57, s60, 8
    s_and_b32 s57, s57, 15
    s_add_u32 s57, s57, s61
    v_mfma_f32_16x16x32_bf16 v[16:19], v[88:91], v[204:207], v[16:19]
    s_mul_i32 s57, s57, 32768
    s_add_u32 s57, s57, s62
    v_mfma_f32_16x16x32_bf16 v[20:23], v[92:95], v[204:207], v[20:23]
    buffer_load_dwordx4 v[204:207], v2, s[8:11], s57 offen offset:2048 sc1
    v_mfma_f32_16x16x32_bf16 v[24:27], v[84:87], v[208:211], v[24:27]
    v_mfma_f32_16x16x32_bf16 v[28:31], v[88:91], v[208:211], v[28:31]
    v_mfma_f32_16x16x32_bf16 v[32:35], v[92:95], v[208:211], v[32:35]
    buffer_load_dwordx4 v[208:211], v2, s[8:11], s57 offen offset:3072 sc1
    s_waitcnt vmcnt(10)
    v_mfma_f32_16x16x32_bf16 v[12:15], v[96:99], v[212:215], v[12:15]
    s_add_u32 s57, s60, 9
    s_and_b32 s57, s57, 15
    s_add_u32 s57, s57, s61
    v_mfma_f32_16x16x32_bf16 v[16:19], v[100:103], v[212:215], v[16:19]
    s_mul_i32 s57, s57, 32768
    s_add_u32 s57, s57, s62
    v_mfma_f32_16x16x32_bf16 v[20:23], v[104:107], v[212:215], v[20:23]
    buffer_load_dwordx4 v[212:215], v2, s[8:11], s57 offen offset:2048 sc1
    v_mfma_f32_16x16x32_bf16 v[24:27], v[96:99], v[216:219], v[24:27]
    v_mfma_f32_16x16x32_bf16 v[28:31], v[100:103], v[216:219], v[28:31]
    v_mfma_f32_16x16x32_bf16 v[32:35], v[104:107], v[216:219], v[32:35]
    buffer_load_dwordx4 v[216:219], v2, s[8:11], s57 offen offset:3072 sc1
    s_waitcnt vmcnt(10)
    v_mfma_f32_16x16x32_bf16 v[12:15], v[108:111], v[220:223], v[12:15]
    s_add_u32 s57, s60, 10
    s_and_b32 s57, s57, 15
    s_add_u32 s57, s57, s61
    v_mfma_f32_16x16x32_bf16 v[16:19], v[112:115], v[220:223], v[16:19]
    s_mul_i32 s57, s57, 32768
    s_add_u32 s57, s57, s62
    v_mfma_f32_16x16x32_bf16 v[20:23], v[116:119], v[220:223], v[20:23]
    buffer_load_dwordx4 v[220:223], v2, s[8:11], s57 offen offset:2048 sc1
    v_mfma_f32_16x16x32_bf16 v[24:27], v[108:111], v[224:227], v[24:27]
    v_mfma_f32_16x16x32_bf16 v[28:31], v[112:115], v[224:227], v[28:31]
    v_mfma_f32_16x16x32_bf16 v[32:35], v[116:119], v[224:227], v[32:35]
    buffer_load_dwordx4 v[224:227], v2, s[8:11], s57 offen offset:3072 sc1
    s_waitcnt vmcnt(10)
    v_mfma_f32_16x16x32_bf16 v[12:15], v[120:123], v[228:231], v[12:15]
    s_add_u32 s57, s60, 11
    s_and_b32 s57, s57, 15
    s_add_u32 s57, s57, s61
    v_mfma_f32_16x16x32_bf16 v[16:19], v[124:127], v[228:231], v[16:19]
    s_mul_i32 s57, s57, 32768
    s_add_u32 s57, s57, s62
    v_mfma_f32_16x16x32_bf16 v[20:23], v[128:131], v[228:231], v[20:23]
    buffer_load_dwordx4 v[228:231], v2, s[8:11], s57 offen offset:2048 sc1
    v_mfma_f32_16x16x32_bf16 v[24:27], v[120:123], v[232:235], v[24:27]
    v_mfma_f32_16x16x32_bf16 v[28:31], v[124:127], v[232:235], v[28:31]
    v_mfma_f32_16x16x32_bf16 v[32:35], v[128:131], v[232:235], v[32:35]
    buffer_load_dwordx4 v[232:235], v2, s[8:11], s57 offen offset:3072 sc1
    s_waitcnt vmcnt(10)
    v_mfma_f32_16x16x32_bf16 v[12:15], v[132:135], v[236:239], v[12:15]
    s_add_u32 s57, s60, 12
    s_and_b32 s57, s57, 15
    s_add_u32 s57, s57, s61
    v_mfma_f32_16x16x32_bf16 v[16:19], v[136:139], v[236:239], v[16:19]
    s_mul_i32 s57, s57, 32768
    s_add_u32 s57, s57, s62
    v_mfma_f32_16x16x32_bf16 v[20:23], v[140:143], v[236:239], v[20:23]
    buffer_load_dwordx4 v[236:239], v2, s[8:11], s57 offen offset:2048 sc1
    v_mfma_f32_16x16x32_bf16 v[24:27], v[132:135], v[240:243], v[24:27]
    v_mfma_f32_16x16x32_bf16 v[28:31], v[136:139], v[240:243], v[28:31]
    v_mfma_f32_16x16x32_bf16 v[32:35], v[140:143], v[240:243], v[32:35]
    buffer_load_dwordx4 v[240:243], v2, s[8:11], s57 offen offset:3072 sc1
    s_waitcnt vmcnt(10)
    v_mfma_f32_16x16x32_bf16 v[12:15], v[144:147], v[244:247], v[12:15]
    s_add_u32 s57, s60, 13
    s_and_b32 s57, s57, 15
    s_add_u32 s57, s57, s61
    v_mfma_f32_16x16x32_bf16 v[16:19], v[148:151], v[244:247], v[16:19]
    s_mul_i32 s57, s57, 32768
    s_add_u32 s57, s57, s62
    v_mfma_f32_16x16x32_bf16 v[20:23], v[152:155], v[244:247], v[20:23]
    buffer_load_dwordx4 v[244:247], v2, s[8:11], s57 offen offset:2048 sc1
    v_mfma_f32_16x16x32_bf16 v[24:27], v[144:147], v[248:251], v[24:27]
    v_mfma_f32_16x16x32_bf16 v[28:31], v[148:151], v[248:251], v[28:31]
    v_mfma_f32_16x16x32_bf16 v[32:35], v[152:155], v[248:251], v[32:35]
    buffer_load_dwordx4 v[248:251], v2, s[8:11], s57 offen offset:3072 sc1
    s_waitcnt vmcnt(10)
    v_mfma_f32_16x16x32_bf16 v[12:15], v[156:159], v[204:207], v[12:15]
    s_add_u32 s57, s60, 14
    s_and_b32 s57, s57, 15
    s_add_u32 s57, s57, s61
    v_mfma_f32_16x16x32_bf16 v[16:19], v[160:163], v[204:207], v[16:19]
    s_mul_i32 s57, s57, 32768
    s_add_u32 s57, s57, s62
    v_mfma_f32_16x16x32_bf16 v[20:23], v[164:167], v[204:207], v[20:23]
    buffer_load_dwordx4 v[204:207], v2, s[8:11], s57 offen offset:2048 sc1
    v_mfma_f32_16x16x32_bf16 v[24:27], v[156:159], v[208:211], v[24:27]
    v_mfma_f32_16x16x32_bf16 v[28:31], v[160:163], v[208:211], v[28:31]
    v_mfma_f32_16x16x32_bf16 v[32:35], v[164:167], v[208:211], v[32:35]
    buffer_load_dwordx4 v[208:211], v2, s[8:11], s57 offen offset:3072 sc1
    s_waitcnt vmcnt(10)
    v_mfma_f32_16x16x32_bf16 v[12:15], v[168:171], v[212:215], v[12:15]
    s_add_u32 s57, s60, 15
    s_and_b32 s57, s57, 15
    s_add_u32 s57, s57, s61
    v_mfma_f32_16x16x32_bf16 v[16:19], v[172:175], v[212:215], v[16:19]
    s_mul_i32 s57, s57, 32768
    s_add_u32 s57, s57, s62
    v_mfma_f32_16x16x32_bf16 v[20:23], v[176:179], v[212:215], v[20:23]
    buffer_load_dwordx4 v[212:215], v2, s[8:11], s57 offen offset:2048 sc1
    v_mfma_f32_16x16x32_bf16 v[24:27], v[168:171], v[216:219], v[24:27]
    v_mfma_f32_16x16x32_bf16 v[28:31], v[172:175], v[216:219], v[28:31]
    v_mfma_f32_16x16x32_bf16 v[32:35], v[176:179], v[216:219], v[32:35]
    buffer_load_dwordx4 v[216:219], v2, s[8:11], s57 offen offset:3072 sc1
    ds_write_b8 v252, v253 offset:44
    s_waitcnt vmcnt(10)
    v_mfma_f32_16x16x32_bf16 v[12:15], v[180:183], v[220:223], v[12:15]
    v_mfma_f32_16x16x32_bf16 v[16:19], v[184:187], v[220:223], v[16:19]
    v_mfma_f32_16x16x32_bf16 v[20:23], v[188:191], v[220:223], v[20:23]
    v_mfma_f32_16x16x32_bf16 v[24:27], v[180:183], v[224:227], v[24:27]
    v_mfma_f32_16x16x32_bf16 v[28:31], v[184:187], v[224:227], v[28:31]
    v_mfma_f32_16x16x32_bf16 v[32:35], v[188:191], v[224:227], v[32:35]
    ds_read_b64_tr_b16 v[36:37], v11 offset:0
    ds_read_b64_tr_b16 v[38:39], v11 offset:1536
    ds_read_b64_tr_b16 v[40:41], v11 offset:32
    ds_read_b64_tr_b16 v[42:43], v11 offset:1568
    ds_read_b64_tr_b16 v[44:45], v11 offset:64
    ds_read_b64_tr_b16 v[46:47], v11 offset:1600
    s_waitcnt vmcnt(8)
    v_mfma_f32_16x16x32_bf16 v[12:15], v[192:195], v[228:231], v[12:15]
    v_mfma_f32_16x16x32_bf16 v[16:19], v[196:199], v[228:231], v[16:19]
    v_mfma_f32_16x16x32_bf16 v[20:23], v[200:203], v[228:231], v[20:23]
    v_mfma_f32_16x16x32_bf16 v[24:27], v[192:195], v[232:235], v[24:27]
    v_mfma_f32_16x16x32_bf16 v[28:31], v[196:199], v[232:235], v[28:31]
    v_mfma_f32_16x16x32_bf16 v[32:35], v[200:203], v[232:235], v[32:35]
    ds_read_b64_tr_b16 v[48:49], v11 offset:3072
    ds_read_b64_tr_b16 v[50:51], v11 offset:4608
    ds_read_b64_tr_b16 v[52:53], v11 offset:3104
    ds_read_b64_tr_b16 v[54:55], v11 offset:4640
    ds_read_b64_tr_b16 v[56:57], v11 offset:3136
    ds_read_b64_tr_b16 v[58:59], v11 offset:4672
    s_waitcnt vmcnt(6) lgkmcnt(6)
    v_mfma_f32_16x16x32_bf16 v[12:15], v[36:39], v[236:239], v[12:15]
    v_mfma_f32_16x16x32_bf16 v[16:19], v[40:43], v[236:239], v[16:19]
    v_mfma_f32_16x16x32_bf16 v[20:23], v[44:47], v[236:239], v[20:23]
    v_mfma_f32_16x16x32_bf16 v[24:27], v[36:39], v[240:243], v[24:27]
    v_mfma_f32_16x16x32_bf16 v[28:31], v[40:43], v[240:243], v[28:31]
    v_mfma_f32_16x16x32_bf16 v[32:35], v[44:47], v[240:243], v[32:35]
    ds_read_b64_tr_b16 v[36:37], v11 offset:6144
    ds_read_b64_tr_b16 v[38:39], v11 offset:7680
    ds_read_b64_tr_b16 v[40:41], v11 offset:6176
    ds_read_b64_tr_b16 v[42:43], v11 offset:7712
    ds_read_b64_tr_b16 v[44:45], v11 offset:6208
    ds_read_b64_tr_b16 v[46:47], v11 offset:7744
    s_waitcnt vmcnt(4) lgkmcnt(6)
    v_mfma_f32_16x16x32_bf16 v[12:15], v[48:51], v[244:247], v[12:15]
    v_mfma_f32_16x16x32_bf16 v[16:19], v[52:55], v[244:247], v[16:19]
    v_mfma_f32_16x16x32_bf16 v[20:23], v[56:59], v[244:247], v[20:23]
    v_mfma_f32_16x16x32_bf16 v[24:27], v[48:51], v[248:251], v[24:27]
    v_mfma_f32_16x16x32_bf16 v[28:31], v[52:55], v[248:251], v[28:31]
    v_mfma_f32_16x16x32_bf16 v[32:35], v[56:59], v[248:251], v[32:35]
    ds_read_b64_tr_b16 v[48:49], v11 offset:9216
    ds_read_b64_tr_b16 v[50:51], v11 offset:10752
    ds_read_b64_tr_b16 v[52:53], v11 offset:9248
    ds_read_b64_tr_b16 v[54:55], v11 offset:10784
    ds_read_b64_tr_b16 v[56:57], v11 offset:9280
    ds_read_b64_tr_b16 v[58:59], v11 offset:10816
    s_waitcnt vmcnt(2) lgkmcnt(6)
    v_mfma_f32_16x16x32_bf16 v[12:15], v[36:39], v[204:207], v[12:15]
    v_mfma_f32_16x16x32_bf16 v[16:19], v[40:43], v[204:207], v[16:19]
    v_mfma_f32_16x16x32_bf16 v[20:23], v[44:47], v[204:207], v[20:23]
    v_mfma_f32_16x16x32_bf16 v[24:27], v[36:39], v[208:211], v[24:27]
    v_mfma_f32_16x16x32_bf16 v[28:31], v[40:43], v[208:211], v[28:31]
    v_mfma_f32_16x16x32_bf16 v[32:35], v[44:47], v[208:211], v[32:35]
    s_waitcnt vmcnt(0) lgkmcnt(0)
    v_mfma_f32_16x16x32_bf16 v[12:15], v[48:51], v[212:215], v[12:15]
    v_mfma_f32_16x16x32_bf16 v[16:19], v[52:55], v[212:215], v[16:19]
    v_mfma_f32_16x16x32_bf16 v[20:23], v[56:59], v[212:215], v[20:23]
    v_mfma_f32_16x16x32_bf16 v[24:27], v[48:51], v[216:219], v[24:27]
    v_mfma_f32_16x16x32_bf16 v[28:31], v[52:55], v[216:219], v[28:31]
    v_mfma_f32_16x16x32_bf16 v[32:35], v[56:59], v[216:219], v[32:35]
    s_nop 2
    ds_write_b128 v254, v[12:15] offset:0
    s_nop 1
    ds_write_b128 v254, v[24:27] offset:1024
    ds_write_b128 v254, v[16:19] offset:2048
    ds_write_b128 v254, v[28:31] offset:3072
    ds_write_b128 v254, v[20:23] offset:4096
    ds_write_b128 v254, v[32:35] offset:5120
    ds_write_b8 v252, v253 offset:64
    s_cmp_eq_u32 s7, 3
    s_cbranch_scc1 L_hout
    s_mov_b32 s58, 0xffff0000
    s_mov_b32 s59, 0xbdd2d3e8
    v_lshlrev_b32 v60, 16, v6
    v_and_b32 v61, s58, v6
    v_lshlrev_b32 v62, 16, v7
    v_and_b32 v63, s58, v7
    v_lshlrev_b32 v64, 16, v8
    v_and_b32 v65, s58, v8
    v_lshlrev_b32 v66, 16, v9
    v_and_b32 v67, s58, v9
    v_mov_b32 v6, 0xc0135761
sp_47:
    ds_read_b32 v3, v1 offset:64
    ds_read_b128 v[76:79], v10 offset:0
    ds_read_b128 v[80:83], v10 offset:256
    ds_read_b128 v[84:87], v10 offset:12288
    ds_read_b128 v[88:91], v10 offset:12544
    ds_read_b128 v[92:95], v10 offset:24576
    ds_read_b128 v[96:99], v10 offset:24832
    ds_read_b128 v[100:103], v10 offset:36864
    ds_read_b128 v[104:107], v10 offset:37120
    s_sub_u32 s47, s47, 1
    s_cselect_b64 s[98:99], -1, 0
    s_andn2_b32 s47, s47, s98
    s_waitcnt lgkmcnt(0)
    v_readfirstlane_b32 s48, v3
    s_nop 0
    s_or_b32 s48, s48, s98
    s_cmp_lt_u32 s48, 0x80808080
    s_cbranch_scc1 sp_47
    v_add_f32 v76, v76, v84
    v_add_f32 v77, v77, v85
    v_add_f32 v78, v78, v86
    v_add_f32 v79, v79, v87
    v_add_f32 v80, v80, v88
    v_add_f32 v81, v81, v89
    v_add_f32 v82, v82, v90
    v_add_f32 v83, v83, v91
    v_add_f32 v92, v92, v100
    v_add_f32 v93, v93, v101
    v_add_f32 v94, v94, v102
    v_add_f32 v95, v95, v103
    v_add_f32 v96, v96, v104
    v_add_f32 v97, v97, v105
    v_add_f32 v98, v98, v106
    v_add_f32 v99, v99, v107
    v_add_f32 v60, v60, v76
    v_add_f32 v61, v61, v77
    v_add_f32 v62, v62, v78
    v_add_f32 v63, v63, v79
    v_add_f32 v64, v64, v80
    v_add_f32 v65, v65, v81
    v_add_f32 v66, v66, v82
    v_add_f32 v67, v67, v83
    v_add_f32 v60, v60, v92
    v_add_f32 v61, v61, v93
    v_add_f32 v62, v62, v94
    v_add_f32 v63, v63, v95
    v_add_f32 v64, v64, v96
    v_add_f32 v65, v65, v97
    v_add_f32 v66, v66, v98
    v_add_f32 v67, v67, v99
    v_mul_f32 v68, v60, v60
    v_mul_f32 v69, v61, v61
    v_mul_f32 v70, v62, v62
    v_mul_f32 v71, v63, v63
    v_mul_f32 v72, v64, v64
    v_mul_f32 v73, v65, v65
    v_mul_f32 v74, v66, v66
    v_mul_f32 v75, v67, v67
    v_fma_f32 v68, v68, s59, v6
    v_fma_f32 v69, v69, s59, v6
    v_fma_f32 v70, v70, s59, v6
    v_fma_f32 v71, v71, s59, v6
    v_fma_f32 v72, v72, s59, v6
    v_fma_f32 v73, v73, s59, v6
    v_fma_f32 v74, v74, s59, v6
    v_fma_f32 v75, v75, s59, v6
    v_mul_f32 v68, v68, v60
    v_mul_f32 v69, v69, v61
    v_mul_f32 v70, v70, v62
    v_mul_f32 v71, v71, v63
    v_mul_f32 v72, v72, v64
    v_mul_f32 v73, v73, v65
    v_mul_f32 v74, v74, v66
    v_mul_f32 v75, v75, v67
    v_exp_f32 v68, v68
    v_exp_f32 v69, v69
    v_exp_f32 v70, v70
    v_exp_f32 v71, v71
    v_exp_f32 v72, v72
    v_exp_f32 v73, v73
    v_exp_f32 v74, v74
    v_exp_f32 v75, v75
    v_add_f32 v68, 1.0, v68
    v_add_f32 v69, 1.0, v69
    v_add_f32 v70, 1.0, v70
    v_add_f32 v71, 1.0, v71
    v_add_f32 v72, 1.0, v72
    v_add_f32 v73, 1.0, v73
    v_add_f32 v74, 1.0, v74
    v_add_f32 v75, 1.0, v75
    v_rcp_f32 v68, v68
    v_rcp_f32 v69, v69
    v_rcp_f32 v70, v70
    v_rcp_f32 v71, v71
    v_rcp_f32 v72, v72
    v_rcp_f32 v73, v73
    v_rcp_f32 v74, v74
    v_rcp_f32 v75, v75
    v_mul_f32 v60, v60, v68
    v_mul_f32 v61, v61, v69
    v_mul_f32 v62, v62, v70
    v_mul_f32 v63, v63, v71
    v_mul_f32 v64, v64, v72
    v_mul_f32 v65, v65, v73
    v_mul_f32 v66, v66, v74
    v_mul_f32 v67, v67, v75
    v_cvt_pk_bf16_f32 v76, v60, v61
    v_cvt_pk_bf16_f32 v77, v62, v63
    v_cvt_pk_bf16_f32 v78, v64, v65
    v_cvt_pk_bf16_f32 v79, v66, v67
    buffer_store_dwordx4 v[76:79], v2, s[8:11], s63 offen sc1
    s_waitcnt vmcnt(0)
    v_mov_b32 v3, 1
    s_mov_b64 exec, 1
    ds_add_rtn_u32 v3, v1, v3 offset:68
    s_mov_b64 exec, -1
    s_waitcnt lgkmcnt(0)
    v_readfirstlane_b32 s48, v3
    s_nop 0
    s_cmp_lg_u32 s48, 2
    s_cbranch_scc1 L_hout
    v_mov_b32 v3, s4
    v_lshlrev_b32 v60, 8, v2
    s_mov_b64 exec, 0xff
    buffer_store_dword v3, v60, s[8:11], s68 offen sc1
    s_mov_b64 exec, -1
    s_branch L_hout
L_hidle:
    v_mov_b32 v5, 4
    s_waitcnt vmcnt(0)
    ds_write_b32 v32, v5 offset:176
lw_48:
    ds_read_b32 v3, v32 offset:192
    s_waitcnt lgkmcnt(0)
    v_readfirstlane_b32 s48, v3
    s_nop 0
    s_cmp_lt_u32 s48, 1
    s_cbranch_scc0 lwd_49
    s_sleep 1
    s_sub_u32 s47, s47, 1
    s_cbranch_scc0 lw_48
    s_mov_b32 s47, 0
lwd_49:
    s_waitcnt vmcnt(0)
    ds_write_b128 v33, v[188:191] offset:0
    ds_write_b128 v33, v[192:195] offset:1024
    ds_write_b128 v33, v[196:199] offset:2048
    ds_write_b128 v33, v[200:203] offset:3072
    ds_write_b128 v33, v[204:207] offset:4096
    ds_write_b128 v33, v[208:211] offset:5120
    ds_write_b128 v33, v[212:215] offset:6144
    ds_write_b128 v33, v[216:219] offset:7168
    ds_write_b128 v33, v[220:223] offset:8192
    ds_write_b128 v33, v[224:227] offset:9216
    ds_write_b128 v33, v[228:231] offset:10240
    ds_write_b128 v33, v[232:235] offset:11264
    ds_write_b128 v33, v[236:239] offset:12288
    ds_write_b128 v33, v[240:243] offset:13312
    ds_write_b128 v33, v[244:247] offset:14336
    ds_write_b128 v33, v[248:251] offset:15360
    v_mov_b32 v3, 1
    s_mov_b64 exec, 1
    ds_add_u32 v1, v3 offset:4
    s_mov_b64 exec, -1
    s_waitcnt lgkmcnt(0)
    v_add_u32 v252, s7, v1
    v_mov_b32 v253, 0x80
    ds_write_b8 v252, v253 offset:120
    ds_write_b8 v252, v253 offset:44
L_hout:
    s_setprio 0
    v_bfe_u32 v6, v0, 2, 6
    v_and_b32 v3, 3, v0
    v_mul_u32_u24 v4, 144, v6
    v_lshl_add_u32 v4, v3, 5, v4
    v_mul_u32_u24 v5, 272, v6
    v_lshl_add_u32 v5, v3, 5, v5
    v_add_u32 v5, 90112, v5
    v_lshlrev_b32 v6, 10, v6
    v_lshl_add_u32 v6, v3, 4, v6
    s_add_u32 s50, s53, s54
    v_add_u32 v100, 45056, v4
bw_50:
    ds_read_b32 v3, v1 offset:80
    s_waitcnt lgkmcnt(0)
    v_readfirstlane_b32 s48, v3
    s_nop 0
    s_cmp_lg_u32 s48, 0x80808080
    s_cbranch_scc0 lwd_51
    s_sleep 1
    s_sub_u32 s47, s47, 1
    s_cbranch_scc0 bw_50
    s_mov_b32 s47, 0
lwd_51:
sp_52:
    ds_read_b32 v3, v1 offset:80
    ds_read_b128 v[60:63], v4 offset:0
    ds_read_b128 v[64:67], v4 offset:16
    ds_read_b128 v[68:71], v4 offset:22528
    ds_read_b128 v[72:75], v4 offset:22544
    ds_read_b128 v[76:79], v100 offset:0
    ds_read_b128 v[80:83], v100 offset:16
    ds_read_b128 v[84:87], v100 offset:22528
    ds_read_b128 v[88:91], v100 offset:22544
    ds_read_b128 v[92:95], v5 offset:0
    ds_read_b128 v[96:99], v5 offset:16
    s_sub_u32 s47, s47, 1
    s_cselect_b64 s[98:99], -1, 0
    s_andn2_b32 s47, s47, s98
    s_waitcnt lgkmcnt(0)
    v_readfirstlane_b32 s48, v3
    s_nop 0
    s_or_b32 s48, s48, s98
    s_cmp_lt_u32 s48, 0x80808080
    s_cbranch_scc1 sp_52
    v_add_f32 v60, v60, v68
    v_add_f32 v61, v61, v69
    v_add_f32 v62, v62, v70
    v_add_f32 v63, v63, v71
    v_add_f32 v64, v64, v72
    v_add_f32 v65, v65, v73
    v_add_f32 v66, v66, v74
    v_add_f32 v67, v67, v75
    v_add_f32 v76, v76, v84
    v_add_f32 v77, v77, v85
    v_add_f32 v78, v78, v86
    v_add_f32 v79, v79, v87
    v_add_f32 v80, v80, v88
    v_add_f32 v81, v81, v89
    v_add_f32 v82, v82, v90
    v_add_f32 v83, v83, v91
    v_add_f32 v60, v60, v92
    v_add_f32 v61, v61, v93
    v_add_f32 v62, v62, v94
    v_add_f32 v63, v63, v95
    v_add_f32 v64, v64, v96
    v_add_f32 v65, v65, v97
    v_add_f32 v66, v66, v98
    v_add_f32 v67, v67, v99
    v_add_f32 v60, v60, v76
    v_add_f32 v61, v61, v77
    v_add_f32 v62, v62, v78
    v_add_f32 v63, v63, v79
    v_add_f32 v64, v64, v80
    v_add_f32 v65, v65, v81
    v_add_f32 v66, v66, v82
    v_add_f32 v67, v67, v83
    v_cvt_pk_bf16_f32 v68, v60, v61
    v_cvt_pk_bf16_f32 v69, v62, v63
    v_cvt_pk_bf16_f32 v70, v64, v65
    v_cvt_pk_bf16_f32 v71, v66, v67
    buffer_store_dwordx4 v[68:71], v6, s[40:43], s50 offen offset:0 sc1
L_hdone:
    s_endpgm
L_compute:
    v_mov_b32 v12, 0
    v_lshl_add_u32 v13, v3, 2, v1
    ds_write_b32 v13, v12
    v_mov_b32 v13, 148224
    ds_write_b32 v13, v12
    ds_write_b32 v13, v12 offset:4
    s_mov_b32 s58, 0x3f803f80
    v_and_b32 v13, 27, v0
    v_cmp_eq_u32 vcc, 16, v13
    v_mov_b32 v13, s58
    s_nop 0
    v_cndmask_b32 v60, 0, v13, vcc
    v_mov_b32 v61, v60
    v_mov_b32 v62, v60
    v_mov_b32 v63, v60
    v_mov_b32 v64, v60
    v_mov_b32 v65, v60
    v_mov_b32 v66, v60
    v_mov_b32 v67, v60
    v_mov_b32 v68, v60
    v_mov_b32 v69, v60
    v_mov_b32 v70, v60
    v_mov_b32 v71, v60
    v_mov_b32 v72, v60
    v_mov_b32 v73, v60
    v_mov_b32 v74, v60
    v_mov_b32 v75, v60
    v_mov_b32 v76, v60
    v_mov_b32 v77, v60
    v_mov_b32 v78, v60
    v_mov_b32 v79, v60
    v_mov_b32 v80, v60
    v_mov_b32 v81, v60
    v_mov_b32 v82, v60
    v_mov_b32 v83, v60
    v_mov_b32 v84, v60
    v_mov_b32 v85, v60
    v_mov_b32 v86, v60
    v_mov_b32 v87, v60
    v_mov_b32 v88, v60
    v_mov_b32 v89, v60
    v_mov_b32 v90, v60
    v_mov_b32 v91, v60
    v_mov_b32 v92, v60
    v_mov_b32 v93, v60
    v_mov_b32 v94, v60
    v_mov_b32 v95, v60
    v_mov_b32 v96, v60
    v_mov_b32 v97, v60
    v_mov_b32 v98, v60
    v_mov_b32 v99, v60
    v_mov_b32 v100, v60
    v_mov_b32 v101, v60
    v_mov_b32 v102, v60
    v_mov_b32 v103, v60
    v_mov_b32 v104, v60
    v_mov_b32 v105, v60
    v_mov_b32 v106, v60
    v_mov_b32 v107, v60
    v_mov_b32 v108, v60
    v_mov_b32 v109, v60
    v_mov_b32 v110, v60
    v_mov_b32 v111, v60
    v_mov_b32 v112, v60
    v_mov_b32 v113, v60
    v_mov_b32 v114, v60
    v_mov_b32 v115, v60
    v_mov_b32 v116, v60
    v_mov_b32 v117, v60
    v_mov_b32 v118, v60
    v_mov_b32 v119, v60
    v_mov_b32 v120, v60
    v_mov_b32 v121, v60
    v_mov_b32 v122, v60
    v_mov_b32 v123, v60
    v_mov_b32 v124, v60
    v_mov_b32 v125, v60
    v_mov_b32 v126, v60
    v_mov_b32 v127, v60
    v_mov_b32 v128, v60
    v_mov_b32 v129, v60
    v_mov_b32 v130, v60
    v_mov_b32 v131, v60
    v_mov_b32 v132, v60
    v_mov_b32 v133, v60
    v_mov_b32 v134, v60
    v_mov_b32 v135, v60
    v_mov_b32 v136, v60
    v_mov_b32 v137, v60
    v_mov_b32 v138, v60
    v_mov_b32 v139, v60
    s_waitcnt lgkmcnt(0)
    s_mov_b32 s8, s82
    s_mov_b32 s9, s83
    s_mov_b32 s10, 0x00b00000
    s_mov_b32 s11, 0x00020000
    s_mov_b32 s28, s76
    s_mov_b32 s29, s77
    s_mov_b32 s30, 0x00560000
    s_mov_b32 s31, 0x00020000
    s_mov_b32 s36, s78
    s_mov_b32 s37, s79
    s_mov_b32 s38, 0x00001000
    s_mov_b32 s39, 0x00020000
    s_mov_b32 s32, s74
    s_mov_b32 s33, s75
    s_mov_b32 s34, 0x00000ac0
    s_mov_b32 s35, 0x00020000
    s_and_b32 s50, s48, 1
    s_lshl_b32 s50, s50, 2
    s_and_b32 s51, s49, 3
    s_add_u32 s44, s50, s51
    s_lshr_b32 s50, s48, 1
    s_lshr_b32 s51, s49, 2
    s_min_u32 s52, s50, 1
    s_add_u32 s51, s51, s52
    s_mul_i32 s50, s50, 7
    s_add_u32 s45, s50, s51
    s_cmp_ge_u32 s51, 8
    s_cselect_b32 s45, 64, s45
    s_mov_b32 s40, s80
    s_mov_b32 s41, s81
    s_mov_b32 s42, 0x00200000
    s_mov_b32 s43, 0x00020000
    s_and_b32 s60, s3, 1
    s_lshr_b32 s61, s3, 1
    v_and_b32 v9, 31, v0
    v_bfe_u32 v10, v0, 5, 1
    s_lshl_b32 s57, s60, 12
    v_bfe_u32 v11, v0, 1, 3
    v_xor_b32 v11, v11, v10
    v_lshlrev_b32 v11, 4, v11
    v_lshl_add_u32 v11, v9, 7, v11
    s_xor_b32 s59, s2, s6
    s_and_b32 s59, s59, 7
    s_lshl_b32 s59, s59, 13
    s_add_u32 s57, s57, s59
    v_add_u32 v4, s57, v11
    v_xor_b32 v5, 32, v4
    v_xor_b32 v6, 64, v4
    v_xor_b32 v7, 96, v4
    v_bfe_u32 v11, v0, 2, 2
    v_lshlrev_b32 v8, 10, v10
    v_lshl_add_u32 v8, v11, 7, v8
    v_lshrrev_b32 v11, 1, v11
    v_xor_b32 v11, s61, v11
    v_lshl_add_u32 v8, v11, 6, v8
    v_bfe_u32 v11, v0, 4, 1
    v_lshl_add_u32 v8, v11, 5, v8
    v_and_b32 v13, 3, v0
    v_lshl_add_u32 v8, v13, 3, v8
    v_add_u32 v8, 65536, v8
    v_and_b32 v13, 7, v0
    v_lshlrev_b32 v14, 2, v11
    v_cmp_eq_u32 vcc, v13, v14
    v_mov_b32 v13, s58
    s_nop 0
    v_cndmask_b32 v15, 0, v13, vcc
    v_mov_b32 v12, v15
    v_mov_b32 v13, v15
    v_mov_b32 v14, v15
    s_mov_b32 s64, 0xffffffff
    s_mov_b32 s65, 0xfffffff0
    s_mov_b32 s66, 0xfffffffe
    s_mov_b32 s67, 0xffffffe0
    s_mov_b32 s68, 0xfffffffc
    s_mov_b32 s69, 0xffffffc0
    s_mov_b32 s70, 0xfffffff8
    s_mov_b32 s71, 0xffffff80
    s_mov_b32 s72, 0xffffff00
    s_mov_b32 s73, 0xfffff000
    s_mov_b32 s74, 0xfffffe00
    s_mov_b32 s75, 0xffffe000
    s_mov_b32 s76, 0xfffffc00
    s_mov_b32 s77, 0xffffc000
    s_mov_b32 s78, 0xfffff800
    s_mov_b32 s79, 0xffff8000
    s_mov_b32 s80, 0xffff0000
    s_mov_b32 s81, 0xfff00000
    s_mov_b32 s82, 0xfffe0000
    s_mov_b32 s83, 0xffe00000
    s_mov_b32 s84, 0xfffc0000
    s_mov_b32 s85, 0xffc00000
    s_mov_b32 s86, 0xfff80000
    s_mov_b32 s87, 0xff800000
    s_mov_b32 s88, 0xff000000
    s_mov_b32 s89, 0xf0000000
    s_mov_b32 s90, 0xfe000000
    s_mov_b32 s91, 0xe0000000
    s_mov_b32 s92, 0xfc000000
    s_mov_b32 s93, 0xc0000000
    s_mov_b32 s94, 0xf8000000
    s_mov_b32 s95, 0x80000000
    s_lshl_b32 s62, s5, 3
    s_add_u32 s62, s62, s6
    s_lshl_b32 s63, s62, 14
    s_lshl_b32 s50, s61, 13
    s_lshl_b32 s51, s60, 11
    s_add_u32 s50, s50, s51
    s_add_u32 s51, s50, s63
    s_add_u32 s52, s51, 4096
    s_add_u32 s50, s50, 131072
    s_lshl_b32 s57, s60, 5
    v_add_u32 v253, s57, v9
    v_lshlrev_b32 v252, 3, v253
    v_add_u32 v252, 147712, v252
    v_mov_b32 v254, 148224
    v_cmp_eq_u32 vcc, 0, v10
    v_lshlrev_b32 v253, 2, v253
    v_add_u32 v253, 147456, v253
    v_cndmask_b32 v252, v254, v252, vcc
    s_lshl_b32 s57, s60, 7
    s_add_u32 s57, s57, 147456
    v_lshlrev_b32 v254, 4, v10
    v_add_u32 v254, s57, v254
    v_and_b32 v9, 15, v0
    v_lshlrev_b32 v9, 4, v9
    v_lshl_add_u32 v9, v10, 8, v9
    v_lshl_add_u32 v10, v11, 12, v9
    s_lshl_b32 s55, s62, 7
    s_add_u32 s55, s55, 10747904
    s_call_b64 s[96:97], L_dry0
    s_mov_b32 s49, 0
    v_add_u32 v11, s3, v1
    v_mov_b32 v52, 0
    v_mov_b32 v53, 0
    v_mov_b32 v54, 0
    v_mov_b32 v55, 0
    v_mov_b32 v56, 0
    v_mov_b32 v57, 0
    v_mov_b32 v58, 0
    v_mov_b32 v59, 0
    s_lshl_b32 s57, s3, 9
    s_add_u32 s57, s57, 148480
    v_lshrrev_b32 v16, 2, v2
    v_add_u32 v16, s57, v16
    v_xor_b32 v17, 512, v16
    s_waitcnt vmcnt(0)
    v_mov_b32 v36, 0x80
    s_barrier
    ds_read_b128 v[140:143], v4
    ds_read_b64_tr_b16 v[156:157], v8 offset:0
    ds_read_b64_tr_b16 v[158:159], v8 offset:512
    ds_read_b64_tr_b16 v[172:173], v8 offset:2048
    ds_read_b64_tr_b16 v[174:175], v8 offset:2560
    ds_read_b128 v[144:147], v5
    ds_read_b64_tr_b16 v[160:161], v8 offset:4096
    ds_read_b64_tr_b16 v[162:163], v8 offset:4608
    ds_read_b64_tr_b16 v[176:177], v8 offset:6144
    ds_read_b64_tr_b16 v[178:179], v8 offset:6656
    ds_read_b128 v[148:151], v6
    ds_read_b64_tr_b16 v[164:165], v8 offset:8192
    ds_read_b64_tr_b16 v[166:167], v8 offset:8704
    ds_read_b64_tr_b16 v[180:181], v8 offset:10240
    ds_read_b64_tr_b16 v[182:183], v8 offset:10752
    ds_read_b128 v[152:155], v7
    ds_read_b64_tr_b16 v[168:169], v8 offset:12288
    ds_read_b64_tr_b16 v[170:171], v8 offset:12800
    ds_read_b64_tr_b16 v[184:185], v8 offset:14336
    ds_read_b64_tr_b16 v[186:187], v8 offset:14848
    s_cmp_lg_u32 s60, 0
    s_cbranch_scc1 L_nb0b
    s_barrier
L_nb0b:
    s_waitcnt lgkmcnt(15)
    v_mfma_f32_32x32x16_bf16 v[236:251], v[156:159], v[140:143], 0
    v_mfma_f32_32x32x16_bf16 v[20:35], v[140:143], v[172:175], 0
    s_waitcnt lgkmcnt(10)
    v_mfma_f32_32x32x16_bf16 v[236:251], v[160:163], v[144:147], v[236:251]
    v_mfma_f32_32x32x16_bf16 v[20:35], v[144:147], v[176:179], v[20:35]
    s_waitcnt lgkmcnt(5)
    v_mfma_f32_32x32x16_bf16 v[236:251], v[164:167], v[148:151], v[236:251]
    v_mfma_f32_32x32x16_bf16 v[20:35], v[148:151], v[180:183], v[20:35]
    s_waitcnt lgkmcnt(0)
    v_mfma_f32_32x32x16_bf16 v[236:251], v[168:171], v[152:155], v[236:251]
    v_mfma_f32_32x32x16_bf16 v[20:35], v[152:155], v[184:187], v[20:35]
    s_cmp_lg_u32 s60, 0
    s_cbranch_scc1 L_cs0b
    v_mfma_f32_16x16x32_bf16 v[52:55], v[12:15], v[156:159], v[52:55]
    v_mfma_f32_16x16x32_bf16 v[56:59], v[12:15], v[172:175], v[56:59]
    v_mfma_f32_16x16x32_bf16 v[52:55], v[12:15], v[160:163], v[52:55]
    v_mfma_f32_16x16x32_bf16 v[56:59], v[12:15], v[176:179], v[56:59]
L_cs0b:
    s_cbranch_scc0 L_cs0e
    v_mfma_f32_16x16x32_bf16 v[52:55], v[12:15], v[164:167], v[52:55]
    v_mfma_f32_16x16x32_bf16 v[56:59], v[12:15], v[180:183], v[56:59]
    v_mfma_f32_16x16x32_bf16 v[52:55], v[12:15], v[168:171], v[52:55]
    v_mfma_f32_16x16x32_bf16 v[56:59], v[12:15], v[184:187], v[56:59]
L_cs0e:
    s_cmp_lg_u32 s60, 1
    s_cbranch_scc1 L_nb1a
    s_barrier
L_nb1a:
    v_xor_b32 v4, 8192, v4
    ds_read_b128 v[188:191], v4
    ds_read_b64_tr_b16 v[204:205], v8 offset:16384
    ds_read_b64_tr_b16 v[206:207], v8 offset:16896
    ds_read_b64_tr_b16 v[220:221], v8 offset:18432
    ds_read_b64_tr_b16 v[222:223], v8 offset:18944
    v_xor_b32 v5, 8192, v5
    ds_read_b128 v[192:195], v5
    ds_read_b64_tr_b16 v[208:209], v8 offset:20480
    ds_read_b64_tr_b16 v[210:211], v8 offset:20992
    ds_read_b64_tr_b16 v[224:225], v8 offset:22528
    ds_read_b64_tr_b16 v[226:227], v8 offset:23040
    v_xor_b32 v6, 8192, v6
    ds_read_b128 v[196:199], v6
    ds_read_b64_tr_b16 v[212:213], v8 offset:24576
    ds_read_b64_tr_b16 v[214:215], v8 offset:25088
    ds_read_b64_tr_b16 v[228:229], v8 offset:26624
    ds_read_b64_tr_b16 v[230:231], v8 offset:27136
    v_xor_b32 v7, 8192, v7
    ds_read_b128 v[200:203], v7
    ds_read_b64_tr_b16 v[216:217], v8 offset:28672
    ds_read_b64_tr_b16 v[218:219], v8 offset:29184
    ds_read_b64_tr_b16 v[232:233], v8 offset:30720
    ds_read_b64_tr_b16 v[234:235], v8 offset:31232
    s_cmp_lg_u32 s60, 0
    s_cbranch_scc1 L_nb1b
    s_barrier
L_nb1b:
    s_waitcnt lgkmcnt(15)
    v_mfma_f32_32x32x16_bf16 v[236:251], v[204:207], v[188:191], v[236:251]
    v_mfma_f32_32x32x16_bf16 v[20:35], v[188:191], v[220:223], v[20:35]
    s_waitcnt lgkmcnt(10)
    v_mfma_f32_32x32x16_bf16 v[236:251], v[208:211], v[192:195], v[236:251]
    v_mfma_f32_32x32x16_bf16 v[20:35], v[192:195], v[224:227], v[20:35]
    s_waitcnt lgkmcnt(5)
    v_mfma_f32_32x32x16_bf16 v[236:251], v[212:215], v[196:199], v[236:251]
    v_mfma_f32_32x32x16_bf16 v[20:35], v[196:199], v[228:231], v[20:35]
    s_waitcnt lgkmcnt(0)
    v_mfma_f32_32x32x16_bf16 v[236:251], v[216:219], v[200:203], v[236:251]
    v_mfma_f32_32x32x16_bf16 v[20:35], v[200:203], v[232:235], v[20:35]
    s_cmp_lg_u32 s60, 0
    s_cbranch_scc1 L_cs1b
    v_mfma_f32_16x16x32_bf16 v[52:55], v[12:15], v[204:207], v[52:55]
    v_mfma_f32_16x16x32_bf16 v[56:59], v[12:15], v[220:223], v[56:59]
    v_mfma_f32_16x16x32_bf16 v[52:55], v[12:15], v[208:211], v[52:55]
    v_mfma_f32_16x16x32_bf16 v[56:59], v[12:15], v[224:227], v[56:59]
L_cs1b:
    s_cbranch_scc0 L_cs1e
    v_mfma_f32_16x16x32_bf16 v[52:55], v[12:15], v[212:215], v[52:55]
    v_mfma_f32_16x16x32_bf16 v[56:59], v[12:15], v[228:231], v[56:59]
    v_mfma_f32_16x16x32_bf16 v[52:55], v[12:15], v[216:219], v[52:55]
    v_mfma_f32_16x16x32_bf16 v[56:59], v[12:15], v[232:235], v[56:59]
L_cs1e:
    s_cmp_lg_u32 s60, 1
    s_cbranch_scc1 L_nb2a
    s_barrier
L_nb2a:
    v_xor_b32 v4, 24576, v4
    ds_read_b128 v[140:143], v4
    ds_read_b64_tr_b16 v[156:157], v8 offset:32768
    ds_read_b64_tr_b16 v[158:159], v8 offset:33280
    ds_read_b64_tr_b16 v[172:173], v8 offset:34816
    ds_read_b64_tr_b16 v[174:175], v8 offset:35328
    v_xor_b32 v5, 24576, v5
    ds_read_b128 v[144:147], v5
    ds_read_b64_tr_b16 v[160:161], v8 offset:36864
    ds_read_b64_tr_b16 v[162:163], v8 offset:37376
    ds_read_b64_tr_b16 v[176:177], v8 offset:38912
    ds_read_b64_tr_b16 v[178:179], v8 offset:39424
    v_xor_b32 v6, 24576, v6
    ds_read_b128 v[148:151], v6
    ds_read_b64_tr_b16 v[164:165], v8 offset:40960
    ds_read_b64_tr_b16 v[166:167], v8 offset:41472
    ds_read_b64_tr_b16 v[180:181], v8 offset:43008
    ds_read_b64_tr_b16 v[182:183], v8 offset:43520
    v_xor_b32 v7, 24576, v7
    ds_read_b128 v[152:155], v7
    ds_read_b64_tr_b16 v[168:169], v8 offset:45056
    ds_read_b64_tr_b16 v[170:171], v8 offset:45568
    ds_read_b64_tr_b16 v[184:185], v8 offset:47104
    ds_read_b64_tr_b16 v[186:187], v8 offset:47616
    s_cmp_lg_u32 s60, 0
    s_cbranch_scc1 L_nb2b
    s_barrier
L_nb2b:
    s_waitcnt lgkmcnt(15)
    v_mfma_f32_32x32x16_bf16 v[236:251], v[156:159], v[140:143], v[236:251]
    v_mfma_f32_32x32x16_bf16 v[20:35], v[140:143], v[172:175], v[20:35]
    s_waitcnt lgkmcnt(10)
    v_mfma_f32_32x32x16_bf16 v[236:251], v[160:163], v[144:147], v[236:251]
    v_mfma_f32_32x32x16_bf16 v[20:35], v[144:147], v[176:179], v[20:35]
    s_waitcnt lgkmcnt(5)
    v_mfma_f32_32x32x16_bf16 v[236:251], v[164:167], v[148:151], v[236:251]
    v_mfma_f32_32x32x16_bf16 v[20:35], v[148:151], v[180:183], v[20:35]
    s_waitcnt lgkmcnt(0)
    v_mfma_f32_32x32x16_bf16 v[236:251], v[168:171], v[152:155], v[236:251]
    v_mfma_f32_32x32x16_bf16 v[20:35], v[152:155], v[184:187], v[20:35]
    s_cmp_lg_u32 s60, 0
    s_cbranch_scc1 L_cs2b
    v_mfma_f32_16x16x32_bf16 v[52:55], v[12:15], v[156:159], v[52:55]
    v_mfma_f32_16x16x32_bf16 v[56:59], v[12:15], v[172:175], v[56:59]
    v_mfma_f32_16x16x32_bf16 v[52:55], v[12:15], v[160:163], v[52:55]
    v_mfma_f32_16x16x32_bf16 v[56:59], v[12:15], v[176:179], v[56:59]
L_cs2b:
    s_cbranch_scc0 L_cs2e
    v_mfma_f32_16x16x32_bf16 v[52:55], v[12:15], v[164:167], v[52:55]
    v_mfma_f32_16x16x32_bf16 v[56:59], v[12:15], v[180:183], v[56:59]
    v_mfma_f32_16x16x32_bf16 v[52:55], v[12:15], v[168:171], v[52:55]
    v_mfma_f32_16x16x32_bf16 v[56:59], v[12:15], v[184:187], v[56:59]
L_cs2e:
    s_cmp_lg_u32 s60, 1
    s_cbranch_scc1 L_nb3a
    s_barrier
L_nb3a:
    v_xor_b32 v4, 8192, v4
    ds_read_b128 v[188:191], v4
    ds_read_b64_tr_b16 v[204:205], v8 offset:49152
    ds_read_b64_tr_b16 v[206:207], v8 offset:49664
    ds_read_b64_tr_b16 v[220:221], v8 offset:51200
    ds_read_b64_tr_b16 v[222:223], v8 offset:51712
    v_xor_b32 v5, 8192, v5
    ds_read_b128 v[192:195], v5
    ds_read_b64_tr_b16 v[208:209], v8 offset:53248
    ds_read_b64_tr_b16 v[210:211], v8 offset:53760
    ds_read_b64_tr_b16 v[224:225], v8 offset:55296
    ds_read_b64_tr_b16 v[226:227], v8 offset:55808
    v_xor_b32 v6, 8192, v6
    ds_read_b128 v[196:199], v6
    ds_read_b64_tr_b16 v[212:213], v8 offset:57344
    ds_read_b64_tr_b16 v[214:215], v8 offset:57856
    ds_read_b64_tr_b16 v[228:229], v8 offset:59392
    ds_read_b64_tr_b16 v[230:231], v8 offset:59904
    v_xor_b32 v7, 8192, v7
    ds_read_b128 v[200:203], v7
    ds_read_b64_tr_b16 v[216:217], v8 offset:61440
    ds_read_b64_tr_b16 v[218:219], v8 offset:61952
    ds_read_b64_tr_b16 v[232:233], v8 offset:63488
    ds_read_b64_tr_b16 v[234:235], v8 offset:64000
    s_cmp_lg_u32 s60, 0
    s_cbranch_scc1 L_nb3b
    s_barrier
L_nb3b:
    s_waitcnt lgkmcnt(15)
    v_mfma_f32_32x32x16_bf16 v[236:251], v[204:207], v[188:191], v[236:251]
    v_mfma_f32_32x32x16_bf16 v[20:35], v[188:191], v[220:223], v[20:35]
    s_waitcnt lgkmcnt(10)
    v_mfma_f32_32x32x16_bf16 v[236:251], v[208:211], v[192:195], v[236:251]
    v_mfma_f32_32x32x16_bf16 v[20:35], v[192:195], v[224:227], v[20:35]
    s_waitcnt lgkmcnt(5)
    v_mfma_f32_32x32x16_bf16 v[236:251], v[212:215], v[196:199], v[236:251]
    v_mfma_f32_32x32x16_bf16 v[20:35], v[196:199], v[228:231], v[20:35]
    s_waitcnt lgkmcnt(0)
    v_mfma_f32_32x32x16_bf16 v[236:251], v[216:219], v[200:203], v[236:251]
    v_mfma_f32_32x32x16_bf16 v[20:35], v[200:203], v[232:235], v[20:35]
    s_cmp_lg_u32 s60, 0
    s_cbranch_scc1 L_cs3b
    v_mfma_f32_16x16x32_bf16 v[52:55], v[12:15], v[204:207], v[52:55]
    v_mfma_f32_16x16x32_bf16 v[56:59], v[12:15], v[220:223], v[56:59]
    v_mfma_f32_16x16x32_bf16 v[52:55], v[12:15], v[208:211], v[52:55]
    v_mfma_f32_16x16x32_bf16 v[56:59], v[12:15], v[224:227], v[56:59]
L_cs3b:
    s_cbranch_scc0 L_cs3e
    v_mfma_f32_16x16x32_bf16 v[52:55], v[12:15], v[212:215], v[52:55]
    v_mfma_f32_16x16x32_bf16 v[56:59], v[12:15], v[228:231], v[56:59]
    v_mfma_f32_16x16x32_bf16 v[52:55], v[12:15], v[216:219], v[52:55]
    v_mfma_f32_16x16x32_bf16 v[56:59], v[12:15], v[232:235], v[56:59]
L_cs3e:
    s_cmp_lg_u32 s60, 1
    s_cbranch_scc1 L_nb4a
    s_barrier
L_nb4a:
    v_xor_b32 v4, 57344, v4
    ds_read_b128 v[140:143], v4
    ds_read_b64_tr_b16 v[156:157], v8 offset:0
    ds_read_b64_tr_b16 v[158:159], v8 offset:512
    ds_read_b64_tr_b16 v[172:173], v8 offset:2048
    ds_read_b64_tr_b16 v[174:175], v8 offset:2560
    v_xor_b32 v5, 57344, v5
    ds_read_b128 v[144:147], v5
    ds_read_b64_tr_b16 v[160:161], v8 offset:4096
    ds_read_b64_tr_b16 v[162:163], v8 offset:4608
    ds_read_b64_tr_b16 v[176:177], v8 offset:6144
    ds_read_b64_tr_b16 v[178:179], v8 offset:6656
    v_xor_b32 v6, 57344, v6
    ds_read_b128 v[148:151], v6
    ds_read_b64_tr_b16 v[164:165], v8 offset:8192
    ds_read_b64_tr_b16 v[166:167], v8 offset:8704
    ds_read_b64_tr_b16 v[180:181], v8 offset:10240
    ds_read_b64_tr_b16 v[182:183], v8 offset:10752
    v_xor_b32 v7, 57344, v7
    ds_read_b128 v[152:155], v7
    ds_read_b64_tr_b16 v[168:169], v8 offset:12288
    ds_read_b64_tr_b16 v[170:171], v8 offset:12800
    ds_read_b64_tr_b16 v[184:185], v8 offset:14336
    ds_read_b64_tr_b16 v[186:187], v8 offset:14848
    s_cmp_lg_u32 s60, 0
    s_cbranch_scc1 L_nb4b
    s_barrier
L_nb4b:
    s_waitcnt lgkmcnt(15)
    v_mfma_f32_32x32x16_bf16 v[236:251], v[156:159], v[140:143], v[236:251]
    v_mfma_f32_32x32x16_bf16 v[20:35], v[140:143], v[172:175], v[20:35]
    s_waitcnt lgkmcnt(10)
    v_mfma_f32_32x32x16_bf16 v[236:251], v[160:163], v[144:147], v[236:251]
    v_mfma_f32_32x32x16_bf16 v[20:35], v[144:147], v[176:179], v[20:35]
    s_waitcnt lgkmcnt(5)
    v_mfma_f32_32x32x16_bf16 v[236:251], v[164:167], v[148:151], v[236:251]
    v_mfma_f32_32x32x16_bf16 v[20:35], v[148:151], v[180:183], v[20:35]
    s_waitcnt lgkmcnt(0)
    v_mfma_f32_32x32x16_bf16 v[236:251], v[168:171], v[152:155], v[236:251]
    v_mfma_f32_32x32x16_bf16 v[20:35], v[152:155], v[184:187], v[20:35]
    s_cmp_lg_u32 s60, 0
    s_cbranch_scc1 L_cs4b
    v_mfma_f32_16x16x32_bf16 v[52:55], v[12:15], v[156:159], v[52:55]
    v_mfma_f32_16x16x32_bf16 v[56:59], v[12:15], v[172:175], v[56:59]
    v_mfma_f32_16x16x32_bf16 v[52:55], v[12:15], v[160:163], v[52:55]
    v_mfma_f32_16x16x32_bf16 v[56:59], v[12:15], v[176:179], v[56:59]
L_cs4b:
    s_cbranch_scc0 L_cs4e
    v_mfma_f32_16x16x32_bf16 v[52:55], v[12:15], v[164:167], v[52:55]
    v_mfma_f32_16x16x32_bf16 v[56:59], v[12:15], v[180:183], v[56:59]
    v_mfma_f32_16x16x32_bf16 v[52:55], v[12:15], v[168:171], v[52:55]
    v_mfma_f32_16x16x32_bf16 v[56:59], v[12:15], v[184:187], v[56:59]
L_cs4e:
    s_cmp_lg_u32 s60, 1
    s_cbranch_scc1 L_nb5a
    s_barrier
L_nb5a:
    v_xor_b32 v4, 8192, v4
    ds_read_b128 v[188:191], v4
    ds_read_b64_tr_b16 v[204:205], v8 offset:16384
    ds_read_b64_tr_b16 v[206:207], v8 offset:16896
    ds_read_b64_tr_b16 v[220:221], v8 offset:18432
    ds_read_b64_tr_b16 v[222:223], v8 offset:18944
    v_xor_b32 v5, 8192, v5
    ds_read_b128 v[192:195], v5
    ds_read_b64_tr_b16 v[208:209], v8 offset:20480
    ds_read_b64_tr_b16 v[210:211], v8 offset:20992
    ds_read_b64_tr_b16 v[224:225], v8 offset:22528
    ds_read_b64_tr_b16 v[226:227], v8 offset:23040
    v_xor_b32 v6, 8192, v6
    ds_read_b128 v[196:199], v6
    ds_read_b64_tr_b16 v[212:213], v8 offset:24576
    ds_read_b64_tr_b16 v[214:215], v8 offset:25088
    ds_read_b64_tr_b16 v[228:229], v8 offset:26624
    ds_read_b64_tr_b16 v[230:231], v8 offset:27136
    v_xor_b32 v7, 8192, v7
    ds_read_b128 v[200:203], v7
    ds_read_b64_tr_b16 v[216:217], v8 offset:28672
    ds_read_b64_tr_b16 v[218:219], v8 offset:29184
    ds_read_b64_tr_b16 v[232:233], v8 offset:30720
    ds_read_b64_tr_b16 v[234:235], v8 offset:31232
    s_cmp_lg_u32 s60, 0
    s_cbranch_scc1 L_nb5b
    s_barrier
L_nb5b:
    s_waitcnt lgkmcnt(15)
    v_mfma_f32_32x32x16_bf16 v[236:251], v[204:207], v[188:191], v[236:251]
    v_mfma_f32_32x32x16_bf16 v[20:35], v[188:191], v[220:223], v[20:35]
    s_waitcnt lgkmcnt(10)
    v_mfma_f32_32x32x16_bf16 v[236:251], v[208:211], v[192:195], v[236:251]
    v_mfma_f32_32x32x16_bf16 v[20:35], v[192:195], v[224:227], v[20:35]
    s_waitcnt lgkmcnt(5)
    v_mfma_f32_32x32x16_bf16 v[236:251], v[212:215], v[196:199], v[236:251]
    v_mfma_f32_32x32x16_bf16 v[20:35], v[196:199], v[228:231], v[20:35]
    s_waitcnt lgkmcnt(0)
    v_mfma_f32_32x32x16_bf16 v[236:251], v[216:219], v[200:203], v[236:251]
    v_mfma_f32_32x32x16_bf16 v[20:35], v[200:203], v[232:235], v[20:35]
    s_cmp_lg_u32 s60, 0
    s_cbranch_scc1 L_cs5b
    v_mfma_f32_16x16x32_bf16 v[52:55], v[12:15], v[204:207], v[52:55]
    v_mfma_f32_16x16x32_bf16 v[56:59], v[12:15], v[220:223], v[56:59]
    v_mfma_f32_16x16x32_bf16 v[52:55], v[12:15], v[208:211], v[52:55]
    v_mfma_f32_16x16x32_bf16 v[56:59], v[12:15], v[224:227], v[56:59]
L_cs5b:
    s_cbranch_scc0 L_cs5e
    v_mfma_f32_16x16x32_bf16 v[52:55], v[12:15], v[212:215], v[52:55]
    v_mfma_f32_16x16x32_bf16 v[56:59], v[12:15], v[228:231], v[56:59]
    v_mfma_f32_16x16x32_bf16 v[52:55], v[12:15], v[216:219], v[52:55]
    v_mfma_f32_16x16x32_bf16 v[56:59], v[12:15], v[232:235], v[56:59]
L_cs5e:
    s_nop 7
    ds_write_b32 v16, v52
    ds_write_b32 v16, v56 offset:256
    s_cmp_lg_u32 s60, 1
    s_cbranch_scc1 L_nb6a
    s_barrier
L_nb6a:
    v_xor_b32 v4, 24576, v4
    ds_read_b128 v[140:143], v4
    ds_read_b64_tr_b16 v[156:157], v8 offset:32768
    ds_read_b64_tr_b16 v[158:159], v8 offset:33280
    ds_read_b64_tr_b16 v[172:173], v8 offset:34816
    ds_read_b64_tr_b16 v[174:175], v8 offset:35328
    v_xor_b32 v5, 24576, v5
    ds_read_b128 v[144:147], v5
    ds_read_b64_tr_b16 v[160:161], v8 offset:36864
    ds_read_b64_tr_b16 v[162:163], v8 offset:37376
    ds_read_b64_tr_b16 v[176:177], v8 offset:38912
    ds_read_b64_tr_b16 v[178:179], v8 offset:39424
    v_xor_b32 v6, 24576, v6
    ds_read_b128 v[148:151], v6
    ds_read_b64_tr_b16 v[164:165], v8 offset:40960
    ds_read_b64_tr_b16 v[166:167], v8 offset:41472
    ds_read_b64_tr_b16 v[180:181], v8 offset:43008
    ds_read_b64_tr_b16 v[182:183], v8 offset:43520
    v_xor_b32 v7, 24576, v7
    ds_read_b128 v[152:155], v7
    ds_read_b64_tr_b16 v[168:169], v8 offset:45056
    ds_read_b64_tr_b16 v[170:171], v8 offset:45568
    ds_read_b64_tr_b16 v[184:185], v8 offset:47104
    ds_read_b64_tr_b16 v[186:187], v8 offset:47616
    s_waitcnt lgkmcnt(15)
    s_cmp_lg_u32 s60, 0
    s_cbranch_scc1 L_nb6b
    s_barrier
L_nb6b:
    s_waitcnt lgkmcnt(15)
    v_mfma_f32_32x32x16_bf16 v[236:251], v[156:159], v[140:143], v[236:251]
    v_mfma_f32_32x32x16_bf16 v[20:35], v[140:143], v[172:175], v[20:35]
    s_waitcnt lgkmcnt(10)
    v_mfma_f32_32x32x16_bf16 v[236:251], v[160:163], v[144:147], v[236:251]
    v_mfma_f32_32x32x16_bf16 v[20:35], v[144:147], v[176:179], v[20:35]
    s_waitcnt lgkmcnt(5)
    v_mfma_f32_32x32x16_bf16 v[236:251], v[164:167], v[148:151], v[236:251]
    v_mfma_f32_32x32x16_bf16 v[20:35], v[148:151], v[180:183], v[20:35]
    s_waitcnt lgkmcnt(0)
    v_mfma_f32_32x32x16_bf16 v[236:251], v[168:171], v[152:155], v[236:251]
    v_mfma_f32_32x32x16_bf16 v[20:35], v[152:155], v[184:187], v[20:35]
    v_mfma_f32_16x16x32_bf16 v[52:55], v[12:15], v[156:159], v[52:55]
    v_mfma_f32_16x16x32_bf16 v[56:59], v[12:15], v[172:175], v[56:59]
    v_mfma_f32_16x16x32_bf16 v[52:55], v[12:15], v[160:163], v[52:55]
    v_mfma_f32_16x16x32_bf16 v[56:59], v[12:15], v[176:179], v[56:59]
    v_mfma_f32_16x16x32_bf16 v[52:55], v[12:15], v[164:167], v[52:55]
    v_mfma_f32_16x16x32_bf16 v[56:59], v[12:15], v[180:183], v[56:59]
    v_mfma_f32_16x16x32_bf16 v[52:55], v[12:15], v[168:171], v[52:55]
    v_mfma_f32_16x16x32_bf16 v[56:59], v[12:15], v[184:187], v[56:59]
    s_cmp_lg_u32 s60, 1
    s_cbranch_scc1 L_nb7a
    s_barrier
L_nb7a:
    v_xor_b32 v4, 8192, v4
    ds_read_b128 v[188:191], v4
    ds_read_b64_tr_b16 v[204:205], v8 offset:49152
    ds_read_b64_tr_b16 v[206:207], v8 offset:49664
    ds_read_b64_tr_b16 v[220:221], v8 offset:51200
    ds_read_b64_tr_b16 v[222:223], v8 offset:51712
    v_xor_b32 v5, 8192, v5
    ds_read_b128 v[192:195], v5
    ds_read_b64_tr_b16 v[208:209], v8 offset:53248
    ds_read_b64_tr_b16 v[210:211], v8 offset:53760
    ds_read_b64_tr_b16 v[224:225], v8 offset:55296
    ds_read_b64_tr_b16 v[226:227], v8 offset:55808
    v_xor_b32 v6, 8192, v6
    ds_read_b128 v[196:199], v6
    ds_read_b64_tr_b16 v[212:213], v8 offset:57344
    ds_read_b64_tr_b16 v[214:215], v8 offset:57856
    ds_read_b64_tr_b16 v[228:229], v8 offset:59392
    ds_read_b64_tr_b16 v[230:231], v8 offset:59904
    v_xor_b32 v7, 8192, v7
    ds_read_b128 v[200:203], v7
    ds_read_b64_tr_b16 v[216:217], v8 offset:61440
    ds_read_b64_tr_b16 v[218:219], v8 offset:61952
    ds_read_b64_tr_b16 v[232:233], v8 offset:63488
    ds_read_b64_tr_b16 v[234:235], v8 offset:64000
    ds_write_b8 v11, v36 offset:124
    s_waitcnt lgkmcnt(0)
    v_mfma_f32_16x16x32_bf16 v[52:55], v[12:15], v[204:207], v[52:55]
    ds_read2_b32 v[18:19], v17 offset0:0 offset1:64
    v_mfma_f32_16x16x32_bf16 v[52:55], v[12:15], v[208:211], v[52:55]
    ds_read_b32 v171, v1 offset:76
    v_mfma_f32_16x16x32_bf16 v[52:55], v[12:15], v[212:215], v[52:55]
    ds_read_b64 v[164:165], v252
    v_mfma_f32_16x16x32_bf16 v[52:55], v[12:15], v[216:219], v[52:55]
    ds_read_b32 v168, v253
    v_mfma_f32_16x16x32_bf16 v[56:59], v[12:15], v[220:223], v[56:59]
    ds_read_b128 v[172:175], v254 offset:0
    v_mfma_f32_16x16x32_bf16 v[56:59], v[12:15], v[224:227], v[56:59]
    ds_read_b128 v[176:179], v254 offset:32
    v_mfma_f32_16x16x32_bf16 v[56:59], v[12:15], v[228:231], v[56:59]
    ds_read_b128 v[180:183], v254 offset:64
    v_mfma_f32_16x16x32_bf16 v[56:59], v[12:15], v[232:235], v[56:59]
    ds_read_b128 v[184:187], v254 offset:96
    v_mov_b32 v166, 0
    v_mov_b32 v167, 0
    s_waitcnt lgkmcnt(7)
    v_mfma_f32_32x32x16_bf16 v[236:251], v[204:207], v[188:191], v[236:251]
    v_add_f32 v169, v52, v18
    v_cvt_pk_bf16_f32 v52, v169, v169
    v_mov_b32 v54, 0
    v_lshlrev_b32 v53, 16, v52
    v_mfma_f32_32x32x16_bf16 v[236:251], v[208:211], v[192:195], v[236:251]
    v_mov_b32 v55, 0
    v_sub_f32 v169, v169, v53
    v_cvt_pk_bf16_f32 v53, v169, 0
    v_add_f32 v170, v56, v19
    v_mfma_f32_32x32x16_bf16 v[236:251], v[212:215], v[196:199], v[236:251]
    v_cvt_pk_bf16_f32 v56, v170, v170
    v_mov_b32 v58, 0
    v_lshlrev_b32 v57, 16, v56
    v_mov_b32 v59, 0
    v_mfma_f32_32x32x16_bf16 v[236:251], v[216:219], v[200:203], v[236:251]
    v_sub_f32 v170, v170, v57
    v_cvt_pk_bf16_f32 v57, v170, 0
    s_waitcnt lgkmcnt(0)
    v_mfma_f32_32x32x16_bf16 v[236:251], v[52:55], v[164:167], v[236:251]
    ds_read_b32 v3, v1 offset:160
    v_mfma_f32_32x32x16_bf16 v[20:35], v[188:191], v[220:223], v[20:35]
    v_mfma_f32_32x32x16_bf16 v[20:35], v[192:195], v[224:227], v[20:35]
    s_nop 8
    v_mul_f32 v236, v236, v168
    v_mul_f32 v237, v237, v168
    v_mul_f32 v238, v238, v168
    v_mul_f32 v239, v239, v168
    v_mul_f32 v240, v240, v168
    v_mul_f32 v241, v241, v168
    v_mfma_f32_32x32x16_bf16 v[20:35], v[196:199], v[228:231], v[20:35]
    v_mul_f32 v242, v242, v168
    v_mul_f32 v243, v243, v168
    v_cvt_pk_bf16_f32 v36, v236, v237
    v_cvt_pk_bf16_f32 v37, v238, v239
    v_cvt_pk_bf16_f32 v38, v240, v241
    v_cvt_pk_bf16_f32 v39, v242, v243
    v_mfma_f32_32x32x16_bf16 v[20:35], v[200:203], v[232:235], v[20:35]
    buffer_store_dwordx4 v[36:39], v2, s[8:11], s51 offen sc1
    v_mul_f32 v244, v244, v168
    v_mul_f32 v245, v245, v168
    v_mul_f32 v246, v246, v168
    v_mul_f32 v247, v247, v168
    v_mul_f32 v248, v248, v168
    v_mfma_f32_32x32x16_bf16 v[20:35], v[164:167], v[56:59], v[20:35]
    v_mul_f32 v249, v249, v168
    v_mul_f32 v250, v250, v168
    v_mul_f32 v251, v251, v168
    v_cvt_pk_bf16_f32 v40, v244, v245
    v_cvt_pk_bf16_f32 v41, v246, v247
    v_cvt_pk_bf16_f32 v42, v248, v249
    v_cvt_pk_bf16_f32 v43, v250, v251
    buffer_store_dwordx4 v[40:43], v2, s[8:11], s52 offen sc1
    v_add_u32 v254, s50, v2
    ds_write_b128 v254, v[36:39] offset:0
    ds_write_b128 v254, v[40:43] offset:4096
    s_nop 0
    v_mul_f32 v20, v20, v172
    v_mul_f32 v21, v21, v173
    v_mul_f32 v22, v22, v174
    v_mul_f32 v23, v23, v175
    v_mul_f32 v24, v24, v176
    v_mul_f32 v25, v25, v177
    v_mul_f32 v26, v26, v178
    v_mul_f32 v27, v27, v179
    v_cvt_pk_bf16_f32 v228, v20, v21
    v_cvt_pk_bf16_f32 v229, v22, v23
    v_cvt_pk_bf16_f32 v230, v24, v25
    v_cvt_pk_bf16_f32 v231, v26, v27
    buffer_store_dwordx4 v[228:231], v10, s[8:11], s51 offen offset:1024 sc1
    v_mul_f32 v28, v28, v180
    v_mul_f32 v29, v29, v181
    v_mul_f32 v30, v30, v182
    v_mul_f32 v31, v31, v183
    v_mul_f32 v32, v32, v184
    v_mul_f32 v33, v33, v185
    v_mul_f32 v34, v34, v186
    v_mul_f32 v35, v35, v187
    v_cvt_pk_bf16_f32 v232, v28, v29
    v_cvt_pk_bf16_f32 v233, v30, v31
    v_cvt_pk_bf16_f32 v234, v32, v33
    v_cvt_pk_bf16_f32 v235, v34, v35
    buffer_store_dwordx4 v[232:235], v10, s[8:11], s51 offen offset:1536 sc1
    s_waitcnt lgkmcnt(0)
    v_readfirstlane_b32 s48, v3
    s_nop 0
    s_cmp_lg_u32 s48, 0x80808080
    s_cbranch_scc1 bt_53
btb_54:
    v_xor_b32 v4, 57344, v4
    ds_read_b128 v[140:143], v4
    ds_read_b64_tr_b16 v[144:145], v8 offset:0
    ds_read_b64_tr_b16 v[146:147], v8 offset:512
    v_xor_b32 v5, 57344, v5
    ds_read_b128 v[148:151], v5
    ds_read_b64_tr_b16 v[152:153], v8 offset:4096
    ds_read_b64_tr_b16 v[154:155], v8 offset:4608
    v_xor_b32 v6, 57344, v6
    ds_read_b128 v[156:159], v6
    ds_read_b64_tr_b16 v[160:161], v8 offset:8192
    ds_read_b64_tr_b16 v[162:163], v8 offset:8704
    s_waitcnt lgkmcnt(6)
    v_mfma_f32_32x32x16_bf16 v[36:51], v[144:147], v[140:143], 0
    v_xor_b32 v7, 57344, v7
    ds_read_b128 v[188:191], v7
    ds_read_b64_tr_b16 v[192:193], v8 offset:12288
    ds_read_b64_tr_b16 v[194:195], v8 offset:12800
    v_xor_b32 v4, 8192, v4
    ds_read_b128 v[196:199], v4
    ds_read_b64_tr_b16 v[200:201], v8 offset:2048
    ds_read_b64_tr_b16 v[202:203], v8 offset:2560
    v_mfma_f32_16x16x32_bf16 v[16:19], v[12:15], v[144:147], 0
    s_waitcnt lgkmcnt(9)
    v_mfma_f32_32x32x16_bf16 v[36:51], v[152:155], v[148:151], v[36:51]
    v_xor_b32 v5, 8192, v5
    ds_read_b128 v[204:207], v5
    ds_read_b64_tr_b16 v[208:209], v8 offset:6144
    ds_read_b64_tr_b16 v[210:211], v8 offset:6656
    ds_read_b32 v169, v1 offset:164
    v_xor_b32 v6, 8192, v6
    ds_read_b128 v[212:215], v6
    ds_read_b64_tr_b16 v[216:217], v8 offset:10240
    ds_read_b64_tr_b16 v[218:219], v8 offset:10752
    v_mfma_f32_16x16x32_bf16 v[16:19], v[12:15], v[152:155], v[16:19]
    v_add_u32 v10, s50, v10
    ds_write_b128 v10, v[228:231] offset:1024
    s_waitcnt lgkmcnt(14)
    v_mfma_f32_32x32x16_bf16 v[36:51], v[160:163], v[156:159], v[36:51]
    v_xor_b32 v7, 8192, v7
    ds_read_b128 v[140:143], v7
    ds_read_b64_tr_b16 v[144:145], v8 offset:14336
    ds_read_b64_tr_b16 v[146:147], v8 offset:14848
    v_mfma_f32_16x16x32_bf16 v[16:19], v[12:15], v[160:163], v[16:19]
    ds_write_b128 v10, v[232:235] offset:1536
    v_mov_b32 v175, 0x80
    s_waitcnt lgkmcnt(15)
    v_mfma_f32_32x32x16_bf16 v[36:51], v[192:195], v[188:191], v[36:51]
    s_waitcnt lgkmcnt(8)
    v_readfirstlane_b32 s48, v169
    s_nop 0
    s_cmp_lg_u32 s48, 0x80808080
    s_cbranch_scc1 bt_56
btb_57:
    v_xor_b32 v4, 24576, v4
    ds_read_b128 v[148:151], v4
    ds_read_b64_tr_b16 v[152:153], v8 offset:16384
    ds_read_b64_tr_b16 v[154:155], v8 offset:16896
    v_mfma_f32_16x16x32_bf16 v[16:19], v[12:15], v[192:195], v[16:19]
    ds_write_b8 v11, v175 offset:116
    s_waitcnt lgkmcnt(15)
    v_mfma_f32_32x32x16_bf16 v[36:51], v[200:203], v[196:199], v[36:51]
    v_xor_b32 v5, 24576, v5
    ds_read_b128 v[156:159], v5
    ds_read_b64_tr_b16 v[160:161], v8 offset:20480
    ds_read_b64_tr_b16 v[162:163], v8 offset:20992
    v_mfma_f32_16x16x32_bf16 v[16:19], v[12:15], v[200:203], v[16:19]
    v_readfirstlane_b32 s4, v171
    v_mul_f32 v168, 0x3eb8aa3b, v168
    s_lshl_b32 s57, s3, 14
    s_waitcnt lgkmcnt(15)
    v_mfma_f32_32x32x16_bf16 v[36:51], v[208:211], v[204:207], v[36:51]
    v_xor_b32 v6, 24576, v6
    ds_read_b128 v[188:191], v6
    ds_read_b64_tr_b16 v[192:193], v8 offset:24576
    ds_read_b64_tr_b16 v[194:195], v8 offset:25088
    v_mfma_f32_16x16x32_bf16 v[16:19], v[12:15], v[208:211], v[16:19]
    s_add_u32 s57, s57, 8192
    v_add_u32 v252, s57, v2
    v_add_u32 v253, s57, v9
    s_waitcnt lgkmcnt(15)
    v_mfma_f32_32x32x16_bf16 v[36:51], v[216:219], v[212:215], v[36:51]
    v_xor_b32 v7, 24576, v7
    ds_read_b128 v[196:199], v7
    ds_read_b64_tr_b16 v[200:201], v8 offset:28672
    ds_read_b64_tr_b16 v[202:203], v8 offset:29184
    v_mfma_f32_16x16x32_bf16 v[16:19], v[12:15], v[216:219], v[16:19]
    s_lshl_b32 s57, s3, 2
    v_add_u32 v254, s57, v1
    v_bfe_u32 v172, v0, 1, 5
    s_waitcnt lgkmcnt(14)
    v_mfma_f32_32x32x16_bf16 v[36:51], v[144:147], v[140:143], v[36:51]
    v_xor_b32 v4, 8192, v4
    ds_read_b128 v[204:207], v4
    ds_read_b64_tr_b16 v[208:209], v8 offset:18432
    ds_read_b64_tr_b16 v[210:211], v8 offset:18944
    v_mfma_f32_16x16x32_bf16 v[16:19], v[12:15], v[144:147], v[16:19]
    v_mul_u32_u24 v173, 4104, v172
    v_and_b32 v174, 1, v0
    v_lshl_add_u32 v173, v174, 7, v173
    s_waitcnt lgkmcnt(13)
    v_mfma_f32_32x32x16_bf16 v[36:51], v[152:155], v[148:151], v[36:51]
    v_xor_b32 v5, 8192, v5
    ds_read_b128 v[212:215], v5
    ds_read_b64_tr_b16 v[216:217], v8 offset:22528
    ds_read_b64_tr_b16 v[218:219], v8 offset:23040
    v_mfma_f32_16x16x32_bf16 v[16:19], v[12:15], v[152:155], v[16:19]
    v_add_u32 v172, s5, v172
    v_cmp_gt_u32 vcc, 31, v172
    v_mov_b32 v172, s4
    s_waitcnt lgkmcnt(12)
    v_mfma_f32_32x32x16_bf16 v[36:51], v[160:163], v[156:159], v[36:51]
    ds_read_b32 v169, v1 offset:168
    v_xor_b32 v6, 8192, v6
    ds_read_b128 v[140:143], v6
    ds_read_b64_tr_b16 v[144:145], v8 offset:26624
    ds_read_b64_tr_b16 v[146:147], v8 offset:27136
    v_mfma_f32_16x16x32_bf16 v[16:19], v[12:15], v[160:163], v[16:19]
    s_and_b64 s[58:59], vcc, 0xff
    s_lshl_b32 s55, s62, 9
    s_lshl_b32 s57, s61, 8
    s_waitcnt lgkmcnt(13)
    v_mfma_f32_32x32x16_bf16 v[36:51], v[192:195], v[188:191], v[36:51]
    v_xor_b32 v7, 8192, v7
    ds_read_b128 v[148:151], v7
    ds_read_b64_tr_b16 v[152:153], v8 offset:30720
    ds_read_b64_tr_b16 v[154:155], v8 offset:31232
    v_mfma_f32_16x16x32_bf16 v[16:19], v[12:15], v[192:195], v[16:19]
    s_add_u32 s55, s55, s57
    s_lshl_b32 s57, s60, 2
    s_add_u32 s55, s55, s57
    s_waitcnt lgkmcnt(13)
    v_mfma_f32_32x32x16_bf16 v[36:51], v[200:203], v[196:199], v[36:51]
    s_waitcnt lgkmcnt(6)
    v_readfirstlane_b32 s48, v169
    s_nop 0
    s_cmp_lg_u32 s48, 0x80808080
    s_cbranch_scc1 bt_59
btb_60:
    v_xor_b32 v4, 57344, v4
    ds_read_b128 v[156:159], v4
    ds_read_b64_tr_b16 v[160:161], v8 offset:32768
    ds_read_b64_tr_b16 v[162:163], v8 offset:33280
    v_mfma_f32_16x16x32_bf16 v[16:19], v[12:15], v[200:203], v[16:19]
    s_add_u32 s55, s55, 10752000
    s_waitcnt lgkmcnt(13)
    v_mfma_f32_32x32x16_bf16 v[36:51], v[208:211], v[204:207], v[36:51]
    v_xor_b32 v5, 57344, v5
    ds_read_b128 v[188:191], v5
    ds_read_b64_tr_b16 v[192:193], v8 offset:36864
    ds_read_b64_tr_b16 v[194:195], v8 offset:37376
    v_mfma_f32_16x16x32_bf16 v[16:19], v[12:15], v[208:211], v[16:19]
    s_waitcnt lgkmcnt(13)
    v_mfma_f32_32x32x16_bf16 v[36:51], v[216:219], v[212:215], v[36:51]
    ds_read_b32 v170, v1 offset:116
    v_xor_b32 v6, 57344, v6
    ds_read_b128 v[196:199], v6
    ds_read_b64_tr_b16 v[200:201], v8 offset:40960
    ds_read_b64_tr_b16 v[202:203], v8 offset:41472
    v_mfma_f32_16x16x32_bf16 v[16:19], v[12:15], v[216:219], v[16:19]
    s_waitcnt lgkmcnt(13)
    v_mfma_f32_32x32x16_bf16 v[36:51], v[144:147], v[140:143], v[36:51]
    v_xor_b32 v7, 57344, v7
    ds_read_b128 v[204:207], v7
    ds_read_b64_tr_b16 v[208:209], v8 offset:45056
    ds_read_b64_tr_b16 v[210:211], v8 offset:45568
    v_mfma_f32_16x16x32_bf16 v[16:19], v[12:15], v[144:147], v[16:19]
    s_waitcnt lgkmcnt(13)
    v_mfma_f32_32x32x16_bf16 v[36:51], v[152:155], v[148:151], v[36:51]
    s_waitcnt lgkmcnt(6)
    v_readfirstlane_b32 s48, v170
    s_nop 0
    s_cmp_lg_u32 s48, 0x80808080
    s_cbranch_scc1 bt_62
btb_63:
    s_lshl_b32 s57, s3, 12
    s_add_u32 s57, s57, 131072
    v_add_u32 v3, s57, v2
    v_add_u32 v10, s57, v9
    ds_read_b128 v[52:55], v3
    ds_read_b128 v[56:59], v3 offset:2048
    s_mov_b32 exec_lo, 0xffff
    s_mov_b32 exec_hi, 0xffff
    ds_read_b128 v[124:127], v10 offset:1024
    ds_read_b128 v[128:131], v10 offset:1536
    ds_read_b128 v[132:135], v10 offset:3072
    ds_read_b128 v[136:139], v10 offset:3584
    s_mov_b64 exec, -1
    v_xor_b32 v4, 8192, v4
    ds_read_b128 v[212:215], v4
    ds_read_b64_tr_b16 v[216:217], v8 offset:34816
    ds_read_b64_tr_b16 v[218:219], v8 offset:35328
    v_mfma_f32_16x16x32_bf16 v[16:19], v[12:15], v[152:155], v[16:19]
    s_waitcnt lgkmcnt(15)
    v_mfma_f32_32x32x16_bf16 v[36:51], v[160:163], v[156:159], v[36:51]
    v_xor_b32 v5, 8192, v5
    ds_read_b128 v[140:143], v5
    ds_read_b64_tr_b16 v[144:145], v8 offset:38912
    ds_read_b64_tr_b16 v[146:147], v8 offset:39424
    v_mfma_f32_16x16x32_bf16 v[16:19], v[12:15], v[160:163], v[16:19]
    s_waitcnt lgkmcnt(15)
    v_mfma_f32_32x32x16_bf16 v[36:51], v[192:195], v[188:191], v[36:51]
    ds_read_b32 v169, v1 offset:172
    v_xor_b32 v6, 8192, v6
    ds_read_b128 v[148:151], v6
    ds_read_b64_tr_b16 v[152:153], v8 offset:43008
    ds_read_b64_tr_b16 v[154:155], v8 offset:43520
    v_mfma_f32_16x16x32_bf16 v[16:19], v[12:15], v[192:195], v[16:19]
    s_waitcnt lgkmcnt(15)
    v_mfma_f32_32x32x16_bf16 v[36:51], v[200:203], v[196:199], v[36:51]
    v_xor_b32 v7, 8192, v7
    ds_read_b128 v[156:159], v7
    ds_read_b64_tr_b16 v[160:161], v8 offset:47104
    ds_read_b64_tr_b16 v[162:163], v8 offset:47616
    v_mfma_f32_16x16x32_bf16 v[16:19], v[12:15], v[200:203], v[16:19]
    s_waitcnt lgkmcnt(15)
    v_mfma_f32_32x32x16_bf16 v[36:51], v[208:211], v[204:207], v[36:51]
    s_waitcnt lgkmcnt(6)
    v_readfirstlane_b32 s48, v169
    s_nop 0
    s_cmp_lg_u32 s48, 0x80808080
    s_cbranch_scc1 bt_65
btb_66:
    v_xor_b32 v4, 24576, v4
    ds_read_b128 v[188:191], v4
    ds_read_b64_tr_b16 v[192:193], v8 offset:49152
    ds_read_b64_tr_b16 v[194:195], v8 offset:49664
    v_mfma_f32_16x16x32_bf16 v[16:19], v[12:15], v[208:211], v[16:19]
    s_waitcnt lgkmcnt(13)
    v_mfma_f32_32x32x16_bf16 v[36:51], v[216:219], v[212:215], v[36:51]
    v_xor_b32 v5, 24576, v5
    ds_read_b128 v[196:199], v5
    ds_read_b64_tr_b16 v[200:201], v8 offset:53248
    ds_read_b64_tr_b16 v[202:203], v8 offset:53760
    v_mfma_f32_16x16x32_bf16 v[16:19], v[12:15], v[216:219], v[16:19]
    s_waitcnt vmcnt(0)
    s_mov_b64 exec, s[58:59]
    s_cbranch_execz L_nokvf
    buffer_store_dword v172, v173, s[8:11], s55 offen sc1
L_nokvf:
    s_mov_b64 exec, -1
    s_and_b32 s57, s5, 3
    s_cmp_eq_u32 s57, 3
    s_cbranch_scc1 L_norel
    v_and_b32 v176, 15, v0
    v_lshlrev_b32 v176, 7, v176
    v_bfe_u32 v177, v0, 4, 1
    v_lshl_add_u32 v176, v177, 12, v176
    s_mov_b32 exec_hi, 0
    buffer_load_dword v251, v176, s[8:11], s51 offen sc1
    s_mov_b64 exec, -1
L_norel:
    s_waitcnt lgkmcnt(13)
    v_mfma_f32_32x32x16_bf16 v[36:51], v[144:147], v[140:143], v[36:51]
    v_xor_b32 v6, 24576, v6
    ds_read_b128 v[204:207], v6
    ds_read_b64_tr_b16 v[208:209], v8 offset:57344
    ds_read_b64_tr_b16 v[210:211], v8 offset:57856
    v_mfma_f32_16x16x32_bf16 v[16:19], v[12:15], v[144:147], v[16:19]
    s_waitcnt lgkmcnt(12)
    v_mfma_f32_32x32x16_bf16 v[36:51], v[152:155], v[148:151], v[36:51]
    v_xor_b32 v7, 24576, v7
    ds_read_b128 v[212:215], v7
    ds_read_b64_tr_b16 v[216:217], v8 offset:61440
    ds_read_b64_tr_b16 v[218:219], v8 offset:61952
    v_mfma_f32_16x16x32_bf16 v[16:19], v[12:15], v[152:155], v[16:19]
    s_waitcnt lgkmcnt(12)
    v_mfma_f32_32x32x16_bf16 v[36:51], v[160:163], v[156:159], v[36:51]
    v_xor_b32 v4, 8192, v4
    ds_read_b128 v[140:143], v4
    ds_read_b64_tr_b16 v[144:145], v8 offset:51200
    ds_read_b64_tr_b16 v[146:147], v8 offset:51712
    v_mfma_f32_16x16x32_bf16 v[16:19], v[12:15], v[160:163], v[16:19]
    s_waitcnt lgkmcnt(12)
    v_mfma_f32_32x32x16_bf16 v[36:51], v[192:195], v[188:191], v[36:51]
    v_xor_b32 v5, 8192, v5
    ds_read_b128 v[148:151], v5
    ds_read_b64_tr_b16 v[152:153], v8 offset:55296
    ds_read_b64_tr_b16 v[154:155], v8 offset:55808
    v_mfma_f32_16x16x32_bf16 v[16:19], v[12:15], v[192:195], v[16:19]
    s_waitcnt lgkmcnt(12)
    v_mfma_f32_32x32x16_bf16 v[36:51], v[200:203], v[196:199], v[36:51]
    v_xor_b32 v6, 8192, v6
    ds_read_b128 v[156:159], v6
    ds_read_b64_tr_b16 v[160:161], v8 offset:59392
    ds_read_b64_tr_b16 v[162:163], v8 offset:59904
    v_mfma_f32_16x16x32_bf16 v[16:19], v[12:15], v[200:203], v[16:19]
    s_waitcnt lgkmcnt(12)
    v_mfma_f32_32x32x16_bf16 v[36:51], v[208:211], v[204:207], v[36:51]
    v_xor_b32 v7, 8192, v7
    ds_read_b128 v[188:191], v7
    ds_read_b64_tr_b16 v[192:193], v8 offset:63488
    ds_read_b64_tr_b16 v[194:195], v8 offset:64000
    v_mfma_f32_16x16x32_bf16 v[16:19], v[12:15], v[208:211], v[16:19]
    s_waitcnt lgkmcnt(12)
    v_mfma_f32_32x32x16_bf16 v[36:51], v[216:219], v[212:215], v[36:51]
    v_mfma_f32_16x16x32_bf16 v[16:19], v[12:15], v[216:219], v[16:19]
    ds_write_b8 v11, v175 offset:112
    s_waitcnt lgkmcnt(10)
    v_mfma_f32_32x32x16_bf16 v[36:51], v[144:147], v[140:143], v[36:51]
    v_mfma_f32_16x16x32_bf16 v[16:19], v[12:15], v[144:147], v[16:19]
    s_waitcnt lgkmcnt(7)
    v_mfma_f32_32x32x16_bf16 v[36:51], v[152:155], v[148:151], v[36:51]
    v_mfma_f32_16x16x32_bf16 v[16:19], v[12:15], v[152:155], v[16:19]
    s_waitcnt lgkmcnt(4)
    v_mfma_f32_32x32x16_bf16 v[36:51], v[160:163], v[156:159], v[36:51]
    v_mfma_f32_16x16x32_bf16 v[16:19], v[12:15], v[160:163], v[16:19]
    s_waitcnt lgkmcnt(1)
    v_mfma_f32_32x32x16_bf16 v[36:51], v[192:195], v[188:191], v[36:51]
    v_mfma_f32_16x16x32_bf16 v[16:19], v[12:15], v[192:195], v[16:19]
    ds_read_b32 v170, v1 offset:112
    s_nop 6
    v_mov_b32 v169, v16
    v_cvt_pk_bf16_f32 v16, v169, v169
    v_mov_b32 v18, 0
    v_lshlrev_b32 v17, 16, v16
    v_mov_b32 v19, 0
    v_sub_f32 v169, v169, v17
    v_cvt_pk_bf16_f32 v17, v169, 0
    s_nop 1
    v_mfma_f32_32x32x16_bf16 v[36:51], v[16:19], v[164:167], v[36:51]
    s_lshl_b32 s57, s61, 12
    s_lshl_b32 s58, s60, 10
    s_add_u32 s57, s57, s58
    s_add_u32 s57, s57, 73728
    v_add_u32 v5, s57, v2
    s_lshl_b32 s57, s3, 11
    s_add_u32 s57, s57, 73728
    v_add_u32 v6, s57, v2
    s_lshl_b32 s57, s3, 2
    v_add_u32 v7, s57, v1
    v_xor_b32 v8, 4, v7
    v_mov_b32 v4, v9
    s_mov_b32 s50, 0xffff
    s_mov_b32 s51, 0xffff
    v_mov_b32 v10, 0xff800000
    v_mov_b32 v11, 0
    v_mov_b32 v3, 1
    s_waitcnt lgkmcnt(0)
    v_readfirstlane_b32 s48, v170
    s_nop 0
    s_cmp_lg_u32 s48, 0x80808080
    s_cbranch_scc1 bt_68
btb_69:
    v_mul_f32 v36, v36, v168
    v_mul_f32 v37, v37, v168
    v_mul_f32 v38, v38, v168
    v_mul_f32 v39, v39, v168
    v_mul_f32 v40, v40, v168
    v_mul_f32 v41, v41, v168
    v_mul_f32 v42, v42, v168
    v_mul_f32 v43, v43, v168
    v_cvt_pk_bf16_f32 v220, v36, v37
    v_cvt_pk_bf16_f32 v221, v38, v39
    v_cvt_pk_bf16_f32 v222, v40, v41
    v_cvt_pk_bf16_f32 v223, v42, v43
    ds_write_b128 v5, v[220:223] offset:0
    v_mul_f32 v44, v44, v168
    v_mul_f32 v45, v45, v168
    v_mul_f32 v46, v46, v168
    v_mul_f32 v47, v47, v168
    v_mul_f32 v48, v48, v168
    v_mul_f32 v49, v49, v168
    v_mul_f32 v50, v50, v168
    v_mul_f32 v51, v51, v168
    v_cvt_pk_bf16_f32 v224, v44, v45
    v_cvt_pk_bf16_f32 v225, v46, v47
    v_cvt_pk_bf16_f32 v226, v48, v49
    v_cvt_pk_bf16_f32 v227, v50, v51
    ds_write_b128 v5, v[224:227] offset:2048
    ds_write_b32 v7, v3 offset:96
    v_cndmask_b32 v140, v10, v11, s[64:65]
    v_cndmask_b32 v141, v10, v11, s[66:67]
    v_cndmask_b32 v142, v10, v11, s[68:69]
    v_cndmask_b32 v143, v10, v11, s[70:71]
    v_cndmask_b32 v144, v10, v11, s[72:73]
    v_cndmask_b32 v145, v10, v11, s[74:75]
    v_cndmask_b32 v146, v10, v11, s[76:77]
    v_cndmask_b32 v147, v10, v11, s[78:79]
    v_cndmask_b32 v148, v10, v11, s[80:81]
    v_cndmask_b32 v149, v10, v11, s[82:83]
    v_cndmask_b32 v150, v10, v11, s[84:85]
    v_cndmask_b32 v151, v10, v11, s[86:87]
    v_cndmask_b32 v152, v10, v11, s[88:89]
    v_cndmask_b32 v153, v10, v11, s[90:91]
    v_cndmask_b32 v154, v10, v11, s[92:93]
    v_cndmask_b32 v155, v10, v11, s[94:95]
    v_cndmask_b32 v156, v10, v11, s[64:65]
    v_cndmask_b32 v157, v10, v11, s[66:67]
    v_cndmask_b32 v158, v10, v11, s[68:69]
    v_cndmask_b32 v159, v10, v11, s[70:71]
    v_cndmask_b32 v160, v10, v11, s[72:73]
    v_cndmask_b32 v161, v10, v11, s[74:75]
    v_cndmask_b32 v162, v10, v11, s[76:77]
    v_cndmask_b32 v163, v10, v11, s[78:79]
    v_cndmask_b32 v164, v10, v11, s[80:81]
    v_cndmask_b32 v165, v10, v11, s[82:83]
    v_cndmask_b32 v166, v10, v11, s[84:85]
    v_cndmask_b32 v167, v10, v11, s[86:87]
    v_cndmask_b32 v168, v10, v11, s[88:89]
    v_cndmask_b32 v169, v10, v11, s[90:91]
    v_cndmask_b32 v170, v10, v11, s[92:93]
    v_cndmask_b32 v171, v10, v11, s[94:95]
sp_71:
    ds_read_b32 v3, v8 offset:96
    ds_read_b128 v[12:15], v6
    ds_read_b128 v[16:19], v6 offset:1024
    s_sub_u32 s47, s47, 1
    s_cselect_b64 s[98:99], -1, 0
    s_andn2_b32 s47, s47, s98
    s_waitcnt lgkmcnt(0)
    v_readfirstlane_b32 s48, v3
    s_nop 0
    s_or_b32 s48, s48, s98
    s_cmp_lt_u32 s48, 1
    s_cbranch_scc1 sp_71
    v_mfma_f32_32x32x16_bf16 v[140:155], v[52:55], v[12:15], v[140:155]
    v_mfma_f32_32x32x16_bf16 v[156:171], v[56:59], v[16:19], v[156:171]
    s_nop 10
    v_max_f32 v6, v140, v141
    v_max3_f32 v6, v142, v143, v6
    v_max3_f32 v6, v144, v145, v6
    v_max3_f32 v6, v146, v147, v6
    v_max3_f32 v6, v148, v149, v6
    v_max3_f32 v6, v150, v151, v6
    v_max3_f32 v6, v152, v153, v6
    v_max3_f32 v6, v154, v155, v6
    v_max_f32 v7, v156, v157
    v_max3_f32 v7, v158, v159, v7
    v_max3_f32 v7, v160, v161, v7
    v_max3_f32 v7, v162, v163, v7
    v_max3_f32 v7, v164, v165, v7
    v_max3_f32 v7, v166, v167, v7
    v_max3_f32 v7, v168, v169, v7
    v_max3_f32 v7, v170, v171, v7
    v_mov_b32 v9, v6
    s_nop 1
    v_permlane32_swap_b32 v6, v9
    v_max_f32 v6, v6, v9
    v_sub_f32 v172, 0, v6
    v_sub_f32 v173, 0, v6
    v_sub_f32 v174, 0, v6
    v_sub_f32 v175, 0, v6
    v_sub_f32 v176, 0, v6
    v_sub_f32 v177, 0, v6
    v_sub_f32 v178, 0, v6
    v_sub_f32 v179, 0, v6
    v_sub_f32 v180, 0, v6
    v_sub_f32 v181, 0, v6
    v_sub_f32 v182, 0, v6
    v_sub_f32 v183, 0, v6
    v_sub_f32 v184, 0, v6
    v_sub_f32 v185, 0, v6
    v_sub_f32 v186, 0, v6
    v_sub_f32 v187, 0, v6
    v_mov_b32 v9, v7
    s_nop 1
    v_permlane32_swap_b32 v7, v9
    v_max_f32 v7, v7, v9
    v_sub_f32 v188, 0, v7
    v_sub_f32 v189, 0, v7
    v_sub_f32 v190, 0, v7
    v_sub_f32 v191, 0, v7
    v_sub_f32 v192, 0, v7
    v_sub_f32 v193, 0, v7
    v_sub_f32 v194, 0, v7
    v_sub_f32 v195, 0, v7
    v_sub_f32 v196, 0, v7
    v_sub_f32 v197, 0, v7
    v_sub_f32 v198, 0, v7
    v_sub_f32 v199, 0, v7
    v_sub_f32 v200, 0, v7
    v_sub_f32 v201, 0, v7
    v_sub_f32 v202, 0, v7
    v_sub_f32 v203, 0, v7
    s_mov_b32 s56, 0
    s_waitcnt vmcnt(0)
L_redo:
    v_cndmask_b32 v140, v10, v172, s[64:65]
    v_cndmask_b32 v141, v10, v172, s[66:67]
    v_cndmask_b32 v142, v10, v172, s[68:69]
    v_cndmask_b32 v143, v10, v172, s[70:71]
    v_cndmask_b32 v144, v10, v172, s[72:73]
    v_cndmask_b32 v145, v10, v172, s[74:75]
    v_cndmask_b32 v146, v10, v172, s[76:77]
    v_cndmask_b32 v147, v10, v172, s[78:79]
    v_cndmask_b32 v148, v10, v172, s[80:81]
    v_cndmask_b32 v149, v10, v172, s[82:83]
    v_cndmask_b32 v150, v10, v172, s[84:85]
    v_cndmask_b32 v151, v10, v172, s[86:87]
    v_cndmask_b32 v152, v10, v172, s[88:89]
    v_cndmask_b32 v153, v10, v172, s[90:91]
    v_cndmask_b32 v154, v10, v172, s[92:93]
    v_cndmask_b32 v155, v10, v172, s[94:95]
    s_nop 1
    v_mfma_f32_32x32x16_bf16 v[140:155], v[52:55], v[12:15], v[140:155]
    s_nop 11
    v_exp_f32 v140, v140
    v_exp_f32 v141, v141
    v_exp_f32 v142, v142
    v_exp_f32 v143, v143
    v_exp_f32 v144, v144
    v_exp_f32 v145, v145
    v_exp_f32 v146, v146
    v_cndmask_b32 v156, v10, v188, s[64:65]
    v_cndmask_b32 v157, v10, v188, s[66:67]
    v_cndmask_b32 v158, v10, v188, s[68:69]
    v_cndmask_b32 v159, v10, v188, s[70:71]
    v_cndmask_b32 v160, v10, v188, s[72:73]
    v_cndmask_b32 v161, v10, v188, s[74:75]
    v_cndmask_b32 v162, v10, v188, s[76:77]
    v_cndmask_b32 v163, v10, v188, s[78:79]
    v_cndmask_b32 v164, v10, v188, s[80:81]
    v_cndmask_b32 v165, v10, v188, s[82:83]
    v_cndmask_b32 v166, v10, v188, s[84:85]
    v_cndmask_b32 v167, v10, v188, s[86:87]
    v_cndmask_b32 v168, v10, v188, s[88:89]
    v_cndmask_b32 v169, v10, v188, s[90:91]
    v_cndmask_b32 v170, v10, v188, s[92:93]
    v_cndmask_b32 v171, v10, v188, s[94:95]
    s_nop 1
    v_mfma_f32_32x32x16_bf16 v[156:171], v[56:59], v[16:19], v[156:171]
    v_exp_f32 v147, v147
    v_cvt_pk_bf16_f32 v204, v140, v141
    v_cvt_pk_bf16_f32 v205, v142, v143
    v_cvt_pk_bf16_f32 v206, v144, v145
    v_cvt_pk_bf16_f32 v207, v146, v147
    v_exp_f32 v148, v148
    v_exp_f32 v149, v149
    v_mfma_f32_32x32x16_bf16 v[220:235], v[124:127], v[204:207], 0
    v_exp_f32 v150, v150
    v_exp_f32 v151, v151
    v_exp_f32 v152, v152
    v_exp_f32 v153, v153
    v_exp_f32 v154, v154
    v_exp_f32 v155, v155
    v_cvt_pk_bf16_f32 v208, v148, v149
    v_cvt_pk_bf16_f32 v209, v150, v151
    v_cvt_pk_bf16_f32 v210, v152, v153
    v_cvt_pk_bf16_f32 v211, v154, v155
    v_exp_f32 v156, v156
    v_exp_f32 v157, v157
    v_mfma_f32_32x32x16_bf16 v[220:235], v[128:131], v[208:211], v[220:235]
    v_exp_f32 v158, v158
    v_exp_f32 v159, v159
    v_exp_f32 v160, v160
    v_exp_f32 v161, v161
    v_mfma_f32_32x32x16_bf16 v[140:155], v[52:55], v[16:19], v[188:203]
    v_exp_f32 v162, v162
    v_exp_f32 v163, v163
    v_cvt_pk_bf16_f32 v212, v156, v157
    v_cvt_pk_bf16_f32 v213, v158, v159
    v_cvt_pk_bf16_f32 v214, v160, v161
    v_cvt_pk_bf16_f32 v215, v162, v163
    v_exp_f32 v164, v164
    v_exp_f32 v165, v165
    v_mfma_f32_32x32x16_bf16 v[236:251], v[132:135], v[212:215], 0
    v_exp_f32 v166, v166
    v_exp_f32 v167, v167
    v_exp_f32 v168, v168
    v_exp_f32 v169, v169
    v_exp_f32 v170, v170
    v_exp_f32 v171, v171
    v_cvt_pk_bf16_f32 v216, v164, v165
    v_cvt_pk_bf16_f32 v217, v166, v167
    v_cvt_pk_bf16_f32 v218, v168, v169
    v_cvt_pk_bf16_f32 v219, v170, v171
    v_exp_f32 v140, v140
    ds_read_b32 v3, v254 offset:176
    v_exp_f32 v141, v141
    v_mfma_f32_32x32x16_bf16 v[236:251], v[136:139], v[216:219], v[236:251]
    v_exp_f32 v142, v142
    v_exp_f32 v143, v143
    v_exp_f32 v144, v144
    v_exp_f32 v145, v145
    v_exp_f32 v146, v146
    v_exp_f32 v147, v147
    v_cvt_pk_bf16_f32 v204, v140, v141
    v_cvt_pk_bf16_f32 v205, v142, v143
    v_cvt_pk_bf16_f32 v206, v144, v145
    v_cvt_pk_bf16_f32 v207, v146, v147
    s_cmp_lg_u32 s56, 0
    s_cbranch_scc1 hs_73
    s_waitcnt lgkmcnt(0)
    v_readfirstlane_b32 s48, v3
    s_nop 0
    s_cmp_lt_u32 s48, 1
    s_cbranch_scc1 hc_72c
hc_72:
    ds_read_b128 v[48:51], v252 offset:2048
    ds_read_b128 v[44:47], v252 offset:0
    s_mov_b64 exec, s[50:51]
    ds_read_b128 v[116:119], v253 offset:3072
    ds_read_b128 v[120:123], v253 offset:3584
    ds_read_b128 v[108:111], v253 offset:1024
    ds_read_b128 v[112:115], v253 offset:1536
    s_mov_b64 exec, -1
hs_73:
    v_exp_f32 v148, v148
    v_exp_f32 v149, v149
    v_mfma_f32_32x32x16_bf16 v[236:251], v[124:127], v[204:207], v[236:251]
    v_exp_f32 v150, v150
    v_exp_f32 v151, v151
    v_exp_f32 v152, v152
    v_exp_f32 v153, v153
    v_exp_f32 v154, v154
    v_exp_f32 v155, v155
    v_cvt_pk_bf16_f32 v208, v148, v149
    v_cvt_pk_bf16_f32 v209, v150, v151
    v_cvt_pk_bf16_f32 v210, v152, v153
    v_cvt_pk_bf16_f32 v211, v154, v155
    s_nop 1
    v_mfma_f32_32x32x16_bf16 v[236:251], v[128:131], v[208:211], v[236:251]
    s_cmp_eq_u32 s5, 0
    s_cbranch_scc1 L_exit8
    s_waitcnt lgkmcnt(0)
    v_mfma_f32_32x32x16_bf16 v[156:171], v[48:51], v[12:15], v[172:187]
    s_nop 11
    v_exp_f32 v156, v156
    ds_read_b32 v3, v254 offset:176
    v_exp_f32 v157, v157
    v_exp_f32 v158, v158
    v_exp_f32 v159, v159
    v_exp_f32 v160, v160
    v_exp_f32 v161, v161
    v_exp_f32 v162, v162
    v_mfma_f32_32x32x16_bf16 v[140:155], v[48:51], v[16:19], v[188:203]
    v_exp_f32 v163, v163
    v_cvt_pk_bf16_f32 v212, v156, v157
    v_cvt_pk_bf16_f32 v213, v158, v159
    v_cvt_pk_bf16_f32 v214, v160, v161
    v_cvt_pk_bf16_f32 v215, v162, v163
    s_cmp_lg_u32 s56, 0
    s_cbranch_scc1 hs_75
    s_waitcnt lgkmcnt(0)
    v_readfirstlane_b32 s48, v3
    s_nop 0
    s_cmp_lt_u32 s48, 2
    s_cbranch_scc1 hc_74c
hc_74:
    ds_read_b128 v[40:43], v252 offset:6144
    ds_read_b128 v[36:39], v252 offset:4096
    s_mov_b64 exec, s[50:51]
    ds_read_b128 v[100:103], v253 offset:7168
    ds_read_b128 v[104:107], v253 offset:7680
    ds_read_b128 v[92:95], v253 offset:5120
    ds_read_b128 v[96:99], v253 offset:5632
    s_mov_b64 exec, -1
hs_75:
    v_exp_f32 v164, v164
    v_exp_f32 v165, v165
    v_mfma_f32_32x32x16_bf16 v[220:235], v[116:119], v[212:215], v[220:235]
    v_exp_f32 v166, v166
    v_exp_f32 v167, v167
    v_exp_f32 v168, v168
    v_exp_f32 v169, v169
    v_exp_f32 v170, v170
    v_exp_f32 v171, v171
    v_cvt_pk_bf16_f32 v216, v164, v165
    v_cvt_pk_bf16_f32 v217, v166, v167
    v_cvt_pk_bf16_f32 v218, v168, v169
    v_cvt_pk_bf16_f32 v219, v170, v171
    v_exp_f32 v140, v140
    v_exp_f32 v141, v141
    v_mfma_f32_32x32x16_bf16 v[220:235], v[120:123], v[216:219], v[220:235]
    v_exp_f32 v142, v142
    v_exp_f32 v143, v143
    v_exp_f32 v144, v144
    v_exp_f32 v145, v145
    v_mfma_f32_32x32x16_bf16 v[156:171], v[44:47], v[12:15], v[172:187]
    v_exp_f32 v146, v146
    v_exp_f32 v147, v147
    v_cvt_pk_bf16_f32 v204, v140, v141
    v_cvt_pk_bf16_f32 v205, v142, v143
    v_cvt_pk_bf16_f32 v206, v144, v145
    v_cvt_pk_bf16_f32 v207, v146, v147
    v_exp_f32 v148, v148
    v_exp_f32 v149, v149
    v_mfma_f32_32x32x16_bf16 v[236:251], v[116:119], v[204:207], v[236:251]
    v_exp_f32 v150, v150
    v_exp_f32 v151, v151
    v_exp_f32 v152, v152
    v_exp_f32 v153, v153
    v_exp_f32 v154, v154
    v_exp_f32 v155, v155
    v_cvt_pk_bf16_f32 v208, v148, v149
    v_cvt_pk_bf16_f32 v209, v150, v151
    v_cvt_pk_bf16_f32 v210, v152, v153
    v_cvt_pk_bf16_f32 v211, v154, v155
    v_exp_f32 v156, v156
    ds_read_b32 v3, v254 offset:176
    v_exp_f32 v157, v157
    v_mfma_f32_32x32x16_bf16 v[236:251], v[120:123], v[208:211], v[236:251]
    v_exp_f32 v158, v158
    v_exp_f32 v159, v159
    v_exp_f32 v160, v160
    v_exp_f32 v161, v161
    v_mfma_f32_32x32x16_bf16 v[140:155], v[44:47], v[16:19], v[188:203]
    v_exp_f32 v162, v162
    v_exp_f32 v163, v163
    v_cvt_pk_bf16_f32 v212, v156, v157
    v_cvt_pk_bf16_f32 v213, v158, v159
    v_cvt_pk_bf16_f32 v214, v160, v161
    s_cmp_lg_u32 s56, 0
    s_cbranch_scc1 hs_77
    s_waitcnt lgkmcnt(0)
    v_readfirstlane_b32 s48, v3
    s_nop 0
    s_cmp_lt_u32 s48, 3
    s_cbranch_scc1 hc_76c
hc_76:
    ds_read_b128 v[32:35], v252 offset:10240
    ds_read_b128 v[28:31], v252 offset:8192
    s_mov_b64 exec, s[50:51]
    ds_read_b128 v[84:87], v253 offset:11264
    ds_read_b128 v[88:91], v253 offset:11776
    ds_read_b128 v[76:79], v253 offset:9216
    ds_read_b128 v[80:83], v253 offset:9728
    s_mov_b64 exec, -1
hs_77:
    v_cvt_pk_bf16_f32 v215, v162, v163
    v_exp_f32 v164, v164
    v_exp_f32 v165, v165
    v_mfma_f32_32x32x16_bf16 v[220:235], v[108:111], v[212:215], v[220:235]
    v_exp_f32 v166, v166
    v_exp_f32 v167, v167
    v_exp_f32 v168, v168
    v_exp_f32 v169, v169
    v_exp_f32 v170, v170
    v_exp_f32 v171, v171
    v_cvt_pk_bf16_f32 v216, v164, v165
    v_cvt_pk_bf16_f32 v217, v166, v167
    v_cvt_pk_bf16_f32 v218, v168, v169
    v_cvt_pk_bf16_f32 v219, v170, v171
    v_exp_f32 v140, v140
    v_exp_f32 v141, v141
    v_mfma_f32_32x32x16_bf16 v[220:235], v[112:115], v[216:219], v[220:235]
    v_exp_f32 v142, v142
    v_exp_f32 v143, v143
    v_exp_f32 v144, v144
    v_exp_f32 v145, v145
    s_waitcnt lgkmcnt(0)
    v_mfma_f32_32x32x16_bf16 v[156:171], v[40:43], v[12:15], v[172:187]
    v_exp_f32 v146, v146
    v_exp_f32 v147, v147
    v_cvt_pk_bf16_f32 v204, v140, v141
    v_cvt_pk_bf16_f32 v205, v142, v143
    v_cvt_pk_bf16_f32 v206, v144, v145
    v_cvt_pk_bf16_f32 v207, v146, v147
    v_exp_f32 v148, v148
    v_exp_f32 v149, v149
    v_mfma_f32_32x32x16_bf16 v[236:251], v[108:111], v[204:207], v[236:251]
    v_exp_f32 v150, v150
    v_exp_f32 v151, v151
    v_exp_f32 v152, v152
    v_exp_f32 v153, v153
    v_exp_f32 v154, v154
    v_exp_f32 v155, v155
    v_cvt_pk_bf16_f32 v208, v148, v149
    v_cvt_pk_bf16_f32 v209, v150, v151
    v_cvt_pk_bf16_f32 v210, v152, v153
    v_cvt_pk_bf16_f32 v211, v154, v155
    s_cmp_eq_u32 s5, 1
    s_cbranch_scc1 L_exit6
    v_exp_f32 v156, v156
    ds_read_b32 v3, v254 offset:176
    v_exp_f32 v157, v157
    v_mfma_f32_32x32x16_bf16 v[236:251], v[112:115], v[208:211], v[236:251]
    v_exp_f32 v158, v158
    v_exp_f32 v159, v159
    v_exp_f32 v160, v160
    v_exp_f32 v161, v161
    v_mfma_f32_32x32x16_bf16 v[140:155], v[40:43], v[16:19], v[188:203]
    v_exp_f32 v162, v162
    v_exp_f32 v163, v163
    v_cvt_pk_bf16_f32 v212, v156, v157
    v_cvt_pk_bf16_f32 v213, v158, v159
    v_cvt_pk_bf16_f32 v214, v160, v161
    s_cmp_lg_u32 s56, 0
    s_cbranch_scc1 hs_79
    s_waitcnt lgkmcnt(0)
    v_readfirstlane_b32 s48, v3
    s_nop 0
    s_cmp_lt_u32 s48, 4
    s_cbranch_scc1 hc_78c
hc_78:
    ds_read_b128 v[24:27], v252 offset:14336
    ds_read_b128 v[20:23], v252 offset:12288
    s_mov_b64 exec, s[50:51]
    ds_read_b128 v[68:71], v253 offset:15360
    ds_read_b128 v[72:75], v253 offset:15872
    ds_read_b128 v[60:63], v253 offset:13312
    ds_read_b128 v[64:67], v253 offset:13824
    s_mov_b64 exec, -1
    ds_write_b32 v254, v1 offset:192
hs_79:
    v_cvt_pk_bf16_f32 v215, v162, v163
    v_exp_f32 v164, v164
    v_exp_f32 v165, v165
    v_mfma_f32_32x32x16_bf16 v[220:235], v[100:103], v[212:215], v[220:235]
    v_exp_f32 v166, v166
    v_exp_f32 v167, v167
    v_exp_f32 v168, v168
    v_exp_f32 v169, v169
    v_exp_f32 v170, v170
    v_exp_f32 v171, v171
    v_cvt_pk_bf16_f32 v216, v164, v165
    v_cvt_pk_bf16_f32 v217, v166, v167
    v_cvt_pk_bf16_f32 v218, v168, v169
    v_cvt_pk_bf16_f32 v219, v170, v171
    v_exp_f32 v140, v140
    v_exp_f32 v141, v141
    v_mfma_f32_32x32x16_bf16 v[220:235], v[104:107], v[216:219], v[220:235]
    v_exp_f32 v142, v142
    v_exp_f32 v143, v143
    v_exp_f32 v144, v144
    v_exp_f32 v145, v145
    v_mfma_f32_32x32x16_bf16 v[156:171], v[36:39], v[12:15], v[172:187]
    v_exp_f32 v146, v146
    v_exp_f32 v147, v147
    v_cvt_pk_bf16_f32 v204, v140, v141
    v_cvt_pk_bf16_f32 v205, v142, v143
    v_cvt_pk_bf16_f32 v206, v144, v145
    v_cvt_pk_bf16_f32 v207, v146, v147
    v_exp_f32 v148, v148
    v_exp_f32 v149, v149
    v_mfma_f32_32x32x16_bf16 v[236:251], v[100:103], v[204:207], v[236:251]
    v_exp_f32 v150, v150
    v_exp_f32 v151, v151
    v_exp_f32 v152, v152
    v_exp_f32 v153, v153
    v_exp_f32 v154, v154
    v_exp_f32 v155, v155
    v_cvt_pk_bf16_f32 v208, v148, v149
    v_cvt_pk_bf16_f32 v209, v150, v151
    v_cvt_pk_bf16_f32 v210, v152, v153
    v_cvt_pk_bf16_f32 v211, v154, v155
    v_exp_f32 v156, v156
    v_exp_f32 v157, v157
    v_mfma_f32_32x32x16_bf16 v[236:251], v[104:107], v[208:211], v[236:251]
    v_exp_f32 v158, v158
    v_exp_f32 v159, v159
    v_exp_f32 v160, v160
    v_exp_f32 v161, v161
    v_mfma_f32_32x32x16_bf16 v[140:155], v[36:39], v[16:19], v[188:203]
    v_exp_f32 v162, v162
    v_exp_f32 v163, v163
    v_cvt_pk_bf16_f32 v212, v156, v157
    v_cvt_pk_bf16_f32 v213, v158, v159
    v_cvt_pk_bf16_f32 v214, v160, v161
    v_cvt_pk_bf16_f32 v215, v162, v163
    v_exp_f32 v164, v164
    v_exp_f32 v165, v165
    v_mfma_f32_32x32x16_bf16 v[220:235], v[92:95], v[212:215], v[220:235]
    v_exp_f32 v166, v166
    v_exp_f32 v167, v167
    v_exp_f32 v168, v168
    v_exp_f32 v169, v169
    v_exp_f32 v170, v170
    v_exp_f32 v171, v171
    v_cvt_pk_bf16_f32 v216, v164, v165
    v_cvt_pk_bf16_f32 v217, v166, v167
    v_cvt_pk_bf16_f32 v218, v168, v169
    v_cvt_pk_bf16_f32 v219, v170, v171
    v_exp_f32 v140, v140
    v_exp_f32 v141, v141
    v_mfma_f32_32x32x16_bf16 v[220:235], v[96:99], v[216:219], v[220:235]
    v_exp_f32 v142, v142
    v_exp_f32 v143, v143
    v_exp_f32 v144, v144
    v_exp_f32 v145, v145
    s_waitcnt lgkmcnt(0)
    v_mfma_f32_32x32x16_bf16 v[156:171], v[32:35], v[12:15], v[172:187]
    v_exp_f32 v146, v146
    v_exp_f32 v147, v147
    v_cvt_pk_bf16_f32 v204, v140, v141
    v_cvt_pk_bf16_f32 v205, v142, v143
    v_cvt_pk_bf16_f32 v206, v144, v145
    v_cvt_pk_bf16_f32 v207, v146, v147
    v_exp_f32 v148, v148
    v_exp_f32 v149, v149
    v_mfma_f32_32x32x16_bf16 v[236:251], v[92:95], v[204:207], v[236:251]
    v_exp_f32 v150, v150
    v_exp_f32 v151, v151
    v_exp_f32 v152, v152
    v_exp_f32 v153, v153
    v_exp_f32 v154, v154
    v_exp_f32 v155, v155
    v_cvt_pk_bf16_f32 v208, v148, v149
    v_cvt_pk_bf16_f32 v209, v150, v151
    v_cvt_pk_bf16_f32 v210, v152, v153
    v_cvt_pk_bf16_f32 v211, v154, v155
    s_cmp_eq_u32 s5, 2
    s_cbranch_scc1 L_exit4
    v_exp_f32 v156, v156
    v_exp_f32 v157, v157
    v_mfma_f32_32x32x16_bf16 v[236:251], v[96:99], v[208:211], v[236:251]
    v_exp_f32 v158, v158
    v_exp_f32 v159, v159
    v_exp_f32 v160, v160
    v_exp_f32 v161, v161
    v_mfma_f32_32x32x16_bf16 v[140:155], v[32:35], v[16:19], v[188:203]
    v_exp_f32 v162, v162
    v_exp_f32 v163, v163
    v_cvt_pk_bf16_f32 v212, v156, v157
    v_cvt_pk_bf16_f32 v213, v158, v159
    v_cvt_pk_bf16_f32 v214, v160, v161
    v_cvt_pk_bf16_f32 v215, v162, v163
    v_exp_f32 v164, v164
    v_exp_f32 v165, v165
    v_mfma_f32_32x32x16_bf16 v[220:235], v[84:87], v[212:215], v[220:235]
    v_exp_f32 v166, v166
    v_exp_f32 v167, v167
    v_exp_f32 v168, v168
    v_exp_f32 v169, v169
    v_exp_f32 v170, v170
    v_exp_f32 v171, v171
    v_cvt_pk_bf16_f32 v216, v164, v165
    v_cvt_pk_bf16_f32 v217, v166, v167
    v_cvt_pk_bf16_f32 v218, v168, v169
    v_cvt_pk_bf16_f32 v219, v170, v171
    v_exp_f32 v140, v140
    v_exp_f32 v141, v141
    v_mfma_f32_32x32x16_bf16 v[220:235], v[88:91], v[216:219], v[220:235]
    v_exp_f32 v142, v142
    v_exp_f32 v143, v143
    v_exp_f32 v144, v144
    v_exp_f32 v145, v145
    v_mfma_f32_32x32x16_bf16 v[156:171], v[28:31], v[12:15], v[172:187]
    v_exp_f32 v146, v146
    v_exp_f32 v147, v147
    v_cvt_pk_bf16_f32 v204, v140, v141
    v_cvt_pk_bf16_f32 v205, v142, v143
    v_cvt_pk_bf16_f32 v206, v144, v145
    v_cvt_pk_bf16_f32 v207, v146, v147
    v_exp_f32 v148, v148
    v_exp_f32 v149, v149
    v_mfma_f32_32x32x16_bf16 v[236:251], v[84:87], v[204:207], v[236:251]
    v_exp_f32 v150, v150
    v_exp_f32 v151, v151
    v_exp_f32 v152, v152
    v_exp_f32 v153, v153
    v_exp_f32 v154, v154
    v_exp_f32 v155, v155
    v_cvt_pk_bf16_f32 v208, v148, v149
    v_cvt_pk_bf16_f32 v209, v150, v151
    v_cvt_pk_bf16_f32 v210, v152, v153
    v_cvt_pk_bf16_f32 v211, v154, v155
    v_exp_f32 v156, v156
    v_exp_f32 v157, v157
    v_mfma_f32_32x32x16_bf16 v[236:251], v[88:91], v[208:211], v[236:251]
    v_exp_f32 v158, v158
    v_exp_f32 v159, v159
    v_exp_f32 v160, v160
    v_exp_f32 v161, v161
    v_mfma_f32_32x32x16_bf16 v[140:155], v[28:31], v[16:19], v[188:203]
    v_exp_f32 v162, v162
    v_exp_f32 v163, v163
    v_cvt_pk_bf16_f32 v212, v156, v157
    v_cvt_pk_bf16_f32 v213, v158, v159
    v_cvt_pk_bf16_f32 v214, v160, v161
    v_cvt_pk_bf16_f32 v215, v162, v163
    v_exp_f32 v164, v164
    v_exp_f32 v165, v165
    v_mfma_f32_32x32x16_bf16 v[220:235], v[76:79], v[212:215], v[220:235]
    v_exp_f32 v166, v166
    v_exp_f32 v167, v167
    v_exp_f32 v168, v168
    v_exp_f32 v169, v169
    v_exp_f32 v170, v170
    v_exp_f32 v171, v171
    v_cvt_pk_bf16_f32 v216, v164, v165
    v_cvt_pk_bf16_f32 v217, v166, v167
    v_cvt_pk_bf16_f32 v218, v168, v169
    v_cvt_pk_bf16_f32 v219, v170, v171
    v_exp_f32 v140, v140
    v_exp_f32 v141, v141
    v_mfma_f32_32x32x16_bf16 v[220:235], v[80:83], v[216:219], v[220:235]
    v_exp_f32 v142, v142
    v_exp_f32 v143, v143
    v_exp_f32 v144, v144
    v_exp_f32 v145, v145
    s_waitcnt lgkmcnt(0)
    v_mfma_f32_32x32x16_bf16 v[156:171], v[24:27], v[12:15], v[172:187]
    v_exp_f32 v146, v146
    v_exp_f32 v147, v147
    v_cvt_pk_bf16_f32 v204, v140, v141
    v_cvt_pk_bf16_f32 v205, v142, v143
    v_cvt_pk_bf16_f32 v206, v144, v145
    v_cvt_pk_bf16_f32 v207, v146, v147
    v_exp_f32 v148, v148
    v_exp_f32 v149, v149
    v_mfma_f32_32x32x16_bf16 v[236:251], v[76:79], v[204:207], v[236:251]
    v_exp_f32 v150, v150
    v_exp_f32 v151, v151
    v_exp_f32 v152, v152
    v_exp_f32 v153, v153
    v_exp_f32 v154, v154
    v_exp_f32 v155, v155
    v_cvt_pk_bf16_f32 v208, v148, v149
    v_cvt_pk_bf16_f32 v209, v150, v151
    v_cvt_pk_bf16_f32 v210, v152, v153
    v_cvt_pk_bf16_f32 v211, v154, v155
    s_cmp_eq_u32 s5, 3
    s_cbranch_scc1 L_exit2
    v_exp_f32 v156, v156
    v_exp_f32 v157, v157
    v_mfma_f32_32x32x16_bf16 v[236:251], v[80:83], v[208:211], v[236:251]
    v_exp_f32 v158, v158
    v_exp_f32 v159, v159
    v_exp_f32 v160, v160
    v_exp_f32 v161, v161
    v_cndmask_b32 v140, v188, v10, s[64:65]
    v_cndmask_b32 v141, v188, v10, s[66:67]
    v_cndmask_b32 v142, v188, v10, s[68:69]
    v_cndmask_b32 v143, v188, v10, s[70:71]
    v_cndmask_b32 v144, v188, v10, s[72:73]
    v_cndmask_b32 v145, v188, v10, s[74:75]
    v_cndmask_b32 v146, v188, v10, s[76:77]
    v_cndmask_b32 v147, v188, v10, s[78:79]
    v_cndmask_b32 v148, v188, v10, s[80:81]
    v_cndmask_b32 v149, v188, v10, s[82:83]
    v_cndmask_b32 v150, v188, v10, s[84:85]
    v_cndmask_b32 v151, v188, v10, s[86:87]
    v_cndmask_b32 v152, v188, v10, s[88:89]
    v_cndmask_b32 v153, v188, v10, s[90:91]
    v_cndmask_b32 v154, v188, v10, s[92:93]
    v_cndmask_b32 v155, v188, v10, s[94:95]
    s_nop 1
    v_mfma_f32_32x32x16_bf16 v[140:155], v[24:27], v[16:19], v[140:155]
    v_exp_f32 v162, v162
    v_exp_f32 v163, v163
    v_cvt_pk_bf16_f32 v212, v156, v157
    v_cvt_pk_bf16_f32 v213, v158, v159
    v_cvt_pk_bf16_f32 v214, v160, v161
    v_cvt_pk_bf16_f32 v215, v162, v163
    v_exp_f32 v164, v164
    v_exp_f32 v165, v165
    v_mfma_f32_32x32x16_bf16 v[220:235], v[68:71], v[212:215], v[220:235]
    v_exp_f32 v166, v166
    v_exp_f32 v167, v167
    v_exp_f32 v168, v168
    v_exp_f32 v169, v169
    v_exp_f32 v170, v170
    v_exp_f32 v171, v171
    v_cvt_pk_bf16_f32 v216, v164, v165
    v_cvt_pk_bf16_f32 v217, v166, v167
    v_cvt_pk_bf16_f32 v218, v168, v169
    v_cvt_pk_bf16_f32 v219, v170, v171
    v_exp_f32 v140, v140
    v_exp_f32 v141, v141
    v_mfma_f32_32x32x16_bf16 v[220:235], v[72:75], v[216:219], v[220:235]
    v_exp_f32 v142, v142
    v_exp_f32 v143, v143
    v_exp_f32 v144, v144
    v_exp_f32 v145, v145
    v_cndmask_b32 v156, v172, v10, s[64:65]
    v_cndmask_b32 v157, v172, v10, s[66:67]
    v_cndmask_b32 v158, v172, v10, s[68:69]
    v_cndmask_b32 v159, v172, v10, s[70:71]
    v_cndmask_b32 v160, v172, v10, s[72:73]
    v_cndmask_b32 v161, v172, v10, s[74:75]
    v_cndmask_b32 v162, v172, v10, s[76:77]
    v_cndmask_b32 v163, v172, v10, s[78:79]
    v_cndmask_b32 v164, v172, v10, s[80:81]
    v_cndmask_b32 v165, v172, v10, s[82:83]
    v_cndmask_b32 v166, v172, v10, s[84:85]
    v_cndmask_b32 v167, v172, v10, s[86:87]
    v_cndmask_b32 v168, v172, v10, s[88:89]
    v_cndmask_b32 v169, v172, v10, s[90:91]
    v_cndmask_b32 v170, v172, v10, s[92:93]
    v_cndmask_b32 v171, v172, v10, s[94:95]
    s_nop 1
    v_mfma_f32_32x32x16_bf16 v[156:171], v[20:23], v[12:15], v[156:171]
    v_exp_f32 v146, v146
    v_exp_f32 v147, v147
    v_cvt_pk_bf16_f32 v204, v140, v141
    v_cvt_pk_bf16_f32 v205, v142, v143
    v_cvt_pk_bf16_f32 v206, v144, v145
    v_cvt_pk_bf16_f32 v207, v146, v147
    v_exp_f32 v148, v148
    v_exp_f32 v149, v149
    v_mfma_f32_32x32x16_bf16 v[236:251], v[68:71], v[204:207], v[236:251]
    v_exp_f32 v150, v150
    v_exp_f32 v151, v151
    v_exp_f32 v152, v152
    v_exp_f32 v153, v153
    v_exp_f32 v154, v154
    v_exp_f32 v155, v155
    v_cvt_pk_bf16_f32 v208, v148, v149
    v_cvt_pk_bf16_f32 v209, v150, v151
    v_cvt_pk_bf16_f32 v210, v152, v153
    v_cvt_pk_bf16_f32 v211, v154, v155
    v_exp_f32 v156, v156
    v_exp_f32 v157, v157
    v_mfma_f32_32x32x16_bf16 v[236:251], v[72:75], v[208:211], v[236:251]
    v_exp_f32 v158, v158
    v_exp_f32 v159, v159
    v_exp_f32 v160, v160
    v_exp_f32 v161, v161
    v_exp_f32 v162, v162
    v_exp_f32 v163, v163
    v_cvt_pk_bf16_f32 v212, v156, v157
    v_cvt_pk_bf16_f32 v213, v158, v159
    v_cvt_pk_bf16_f32 v214, v160, v161
    v_cvt_pk_bf16_f32 v215, v162, v163
    v_exp_f32 v164, v164
    v_exp_f32 v165, v165
    v_mfma_f32_32x32x16_bf16 v[220:235], v[60:63], v[212:215], v[220:235]
    v_exp_f32 v166, v166
    v_exp_f32 v167, v167
    v_exp_f32 v168, v168
    v_exp_f32 v169, v169
    v_exp_f32 v170, v170
    v_exp_f32 v171, v171
    v_cvt_pk_bf16_f32 v216, v164, v165
    v_cvt_pk_bf16_f32 v217, v166, v167
    v_cvt_pk_bf16_f32 v218, v168, v169
    v_cvt_pk_bf16_f32 v219, v170, v171
    s_nop 1
    v_mfma_f32_32x32x16_bf16 v[220:235], v[64:67], v[216:219], v[220:235]
L_bdone:
    s_lshl_b32 s57, s6, 2
    s_add_u32 s57, s57, s3
    s_lshl_b32 s57, s57, 10
    s_add_u32 s57, s57, s53
    s_add_u32 s57, s57, 4194304
    s_add_u32 s58, s57, 32768
    ds_read_b32 v3, v1 offset:12
    ds_read_b32 v252, v1 offset:4
    v_mov_b32 v8, 0x4e800000
    s_nop 3
    v_add_f32 v9, v244, v228
    v_cmp_nle_f32 vcc, v9, v8
    v_rcp_f32 v9, v244
    v_rcp_f32 v8, v228
    s_cmp_lg_u64 vcc, 0
    s_cbranch_scc1 L_fallback
L_bok:
    v_mul_f32 v236, v236, v9
    v_mul_f32 v237, v237, v9
    v_mul_f32 v238, v238, v9
    v_mul_f32 v239, v239, v9
    v_mul_f32 v240, v240, v9
    v_mul_f32 v241, v241, v9
    v_mul_f32 v242, v242, v9
    v_mul_f32 v243, v243, v9
    v_cvt_pk_bf16_f32 v208, v236, v237
    v_cvt_pk_bf16_f32 v209, v238, v239
    v_cvt_pk_bf16_f32 v210, v240, v241
    v_cvt_pk_bf16_f32 v211, v242, v243
    v_mul_f32 v220, v220, v8
    v_mul_f32 v221, v221, v8
    v_mul_f32 v222, v222, v8
    v_mul_f32 v223, v223, v8
    v_mul_f32 v224, v224, v8
    v_mul_f32 v225, v225, v8
    v_mul_f32 v226, v226, v8
    v_mul_f32 v227, v227, v8
    v_cvt_pk_bf16_f32 v204, v220, v221
    v_cvt_pk_bf16_f32 v205, v222, v223
    v_cvt_pk_bf16_f32 v206, v224, v225
    v_cvt_pk_bf16_f32 v207, v226, v227
    s_waitcnt vmcnt(0) lgkmcnt(0)
    v_readfirstlane_b32 s46, v3
    s_nop 0
    s_lshr_b32 s46, s46, 1
    s_cmp_lg_u32 s46, 0
    s_cbranch_scc0 sf_80
    buffer_store_dwordx4 v[204:207], v2, s[8:11], s57 offen
    buffer_store_dwordx4 v[208:211], v2, s[8:11], s58 offen
sd_81:
    v_readfirstlane_b32 s48, v252
    v_and_b32 v6, 31, v0
    v_bfe_u32 v7, v0, 5, 1
    v_bfe_u32 v9, v0, 2, 2
    v_lshlrev_b32 v10, 9, v7
    v_lshl_add_u32 v10, v9, 7, v10
    v_bfe_u32 v11, v0, 4, 1
    v_lshl_add_u32 v10, v11, 5, v10
    v_and_b32 v11, 3, v0
    v_lshl_add_u32 v10, v11, 3, v10
    v_lshrrev_b32 v9, 1, v9
    v_xor_b32 v9, s61, v9
    v_lshl_add_u32 v4, v9, 6, v10
    s_lshl_b32 s57, s61, 15
    s_add_u32 s57, s57, 8192
    v_add_u32 v4, s57, v4
    v_xor_b32 v5, 64, v4
    s_cmp_ge_u32 s48, 4
    s_cbranch_scc1 L_wook
sp_82:
    ds_read_b32 v3, v1 offset:4
    s_sub_u32 s47, s47, 1
    s_cselect_b64 s[98:99], -1, 0
    s_andn2_b32 s47, s47, s98
    s_waitcnt lgkmcnt(0)
    v_readfirstlane_b32 s48, v3
    s_nop 0
    s_or_b32 s48, s48, s98
    s_cmp_lt_u32 s48, 4
    s_cbranch_scc1 sp_82
L_wook:
    ds_read_b64_tr_b16 v[44:45], v4 offset:0
    ds_read_b64_tr_b16 v[46:47], v4 offset:1024
    ds_read_b64_tr_b16 v[48:49], v5 offset:0
    ds_read_b64_tr_b16 v[50:51], v5 offset:1024
    ds_read_b64_tr_b16 v[52:53], v4 offset:2048
    ds_read_b64_tr_b16 v[54:55], v4 offset:3072
    ds_read_b64_tr_b16 v[56:57], v5 offset:2048
    ds_read_b64_tr_b16 v[58:59], v5 offset:3072
    ds_read_b64_tr_b16 v[60:61], v4 offset:4096
    ds_read_b64_tr_b16 v[62:63], v4 offset:5120
    ds_read_b64_tr_b16 v[64:65], v5 offset:4096
    ds_read_b64_tr_b16 v[66:67], v5 offset:5120
    ds_read_b64_tr_b16 v[68:69], v4 offset:6144
    ds_read_b64_tr_b16 v[70:71], v4 offset:7168
    ds_read_b64_tr_b16 v[72:73], v5 offset:6144
    ds_read_b64_tr_b16 v[74:75], v5 offset:7168
    ds_read_b64_tr_b16 v[76:77], v4 offset:8192
    ds_read_b64_tr_b16 v[78:79], v4 offset:9216
    ds_read_b64_tr_b16 v[80:81], v5 offset:8192
    ds_read_b64_tr_b16 v[82:83], v5 offset:9216
    ds_read_b64_tr_b16 v[84:85], v4 offset:10240
    ds_read_b64_tr_b16 v[86:87], v4 offset:11264
    ds_read_b64_tr_b16 v[88:89], v5 offset:10240
    ds_read_b64_tr_b16 v[90:91], v5 offset:11264
    ds_read_b64_tr_b16 v[92:93], v4 offset:12288
    ds_read_b64_tr_b16 v[94:95], v4 offset:13312
    ds_read_b64_tr_b16 v[96:97], v5 offset:12288
    ds_read_b64_tr_b16 v[98:99], v5 offset:13312
    ds_read_b64_tr_b16 v[100:101], v4 offset:14336
    ds_read_b64_tr_b16 v[102:103], v4 offset:15360
    ds_read_b64_tr_b16 v[104:105], v5 offset:14336
    ds_read_b64_tr_b16 v[106:107], v5 offset:15360
    s_lshl_b32 s50, s5, 7
    s_add_u32 s50, s50, 10493952
    s_lshl_b32 s57, s6, 2
    s_add_u32 s57, s57, s3
    s_lshl_b32 s57, s57, 2
    s_add_u32 s57, s57, s50
    v_and_b32 v8, 15, v0
    v_lshlrev_b32 v8, 2, v8
    s_waitcnt vmcnt(0)
    v_mov_b32 v3, s4
    s_mov_b64 exec, 1
    s_cmp_lg_u32 s46, 0
    s_cbranch_scc0 sf_83
    buffer_store_dword v3, v2, s[8:11], s57 offen
sd_84:
    s_mov_b64 exec, -1
    s_lshl_b32 s58, s61, 6
    s_add_u32 s57, s50, s58
    buffer_load_dword v253, v8, s[8:11], s57 offen sc1
    ds_read_b64_tr_b16 v[108:109], v4 offset:16384
    ds_read_b64_tr_b16 v[110:111], v4 offset:17408
    ds_read_b64_tr_b16 v[112:113], v5 offset:16384
    ds_read_b64_tr_b16 v[114:115], v5 offset:17408
    ds_read_b64_tr_b16 v[116:117], v4 offset:18432
    ds_read_b64_tr_b16 v[118:119], v4 offset:19456
    ds_read_b64_tr_b16 v[120:121], v5 offset:18432
    ds_read_b64_tr_b16 v[122:123], v5 offset:19456
    ds_read_b64_tr_b16 v[124:125], v4 offset:20480
    ds_read_b64_tr_b16 v[126:127], v4 offset:21504
    ds_read_b64_tr_b16 v[128:129], v5 offset:20480
    ds_read_b64_tr_b16 v[130:131], v5 offset:21504
    ds_read_b64_tr_b16 v[132:133], v4 offset:22528
    ds_read_b64_tr_b16 v[134:135], v4 offset:23552
    ds_read_b64_tr_b16 v[136:137], v5 offset:22528
    ds_read_b64_tr_b16 v[138:139], v5 offset:23552
    ds_read_b64_tr_b16 v[140:141], v4 offset:24576
    ds_read_b64_tr_b16 v[142:143], v4 offset:25600
    ds_read_b64_tr_b16 v[144:145], v5 offset:24576
    ds_read_b64_tr_b16 v[146:147], v5 offset:25600
    ds_read_b64_tr_b16 v[148:149], v4 offset:26624
    ds_read_b64_tr_b16 v[150:151], v4 offset:27648
    ds_read_b64_tr_b16 v[152:153], v5 offset:26624
    ds_read_b64_tr_b16 v[154:155], v5 offset:27648
    ds_read_b64_tr_b16 v[156:157], v4 offset:28672
    ds_read_b64_tr_b16 v[158:159], v4 offset:29696
    ds_read_b64_tr_b16 v[160:161], v5 offset:28672
    ds_read_b64_tr_b16 v[162:163], v5 offset:29696
    ds_read_b64_tr_b16 v[164:165], v4 offset:30720
    ds_read_b64_tr_b16 v[166:167], v4 offset:31744
    ds_read_b64_tr_b16 v[168:169], v5 offset:30720
    ds_read_b64_tr_b16 v[170:171], v5 offset:31744
    v_bfe_u32 v9, v0, 1, 3
    s_lshl_b32 s58, s61, 2
    v_xor_b32 v9, s58, v9
    v_lshlrev_b32 v4, 7, v6
    v_lshl_add_u32 v4, v7, 3, v4
    v_lshl_add_u32 v4, v9, 4, v4
    s_lshl_b32 s58, s60, 12
    s_add_u32 s58, s58, 0
    v_add_u32 v4, s58, v4
    v_xor_b32 v9, 0, v4
    ds_read_b64 v[28:29], v9
    v_xor_b32 v9, 16, v4
    ds_read_b64 v[30:31], v9
    v_xor_b32 v9, 32, v4
    ds_read_b64 v[32:33], v9
    v_xor_b32 v9, 48, v4
    ds_read_b64 v[34:35], v9
    s_lshl_b32 s58, s60, 15
    s_lshl_b32 s50, s61, 14
    s_add_u32 s58, s58, s50
    s_add_u32 s58, s58, s53
    s_add_u32 s58, s58, 4194304
    s_waitcnt vmcnt(0)
    v_cmp_ne_u32 vcc, s4, v253
    s_nop 0
    s_cmp_eq_u64 vcc, 0
    s_cbranch_scc1 L_ook
pl_85:
    buffer_load_dword v3, v8, s[8:11], s57 offen sc1
    s_sub_u32 s47, s47, 1
    s_cselect_b64 s[98:99], -1, 0
    s_andn2_b32 s47, s47, s98
    s_waitcnt vmcnt(0)
    v_cmp_ne_u32 vcc, s4, v3
    s_nop 0
    s_andn2_b64 vcc, vcc, s[98:99]
    s_cbranch_scc1 pl_85
L_ook:
    buffer_load_dwordx4 v[172:175], v2, s[8:11], s58 offen offset:0 sc1
    buffer_load_dwordx4 v[176:179], v2, s[8:11], s58 offen offset:1024 sc1
    buffer_load_dwordx4 v[180:183], v2, s[8:11], s58 offen offset:2048 sc1
    buffer_load_dwordx4 v[184:187], v2, s[8:11], s58 offen offset:3072 sc1
    s_add_u32 s58, s58, 4096
    buffer_load_dwordx4 v[188:191], v2, s[8:11], s58 offen offset:0 sc1
    buffer_load_dwordx4 v[192:195], v2, s[8:11], s58 offen offset:1024 sc1
    buffer_load_dwordx4 v[196:199], v2, s[8:11], s58 offen offset:2048 sc1
    s_mov_b32 s59, 0xffff0000
    s_waitcnt lgkmcnt(0)
    v_lshlrev_b32 v12, 16, v28
    v_and_b32 v13, s59, v28
    v_lshlrev_b32 v14, 16, v29
    v_and_b32 v15, s59, v29
    v_lshlrev_b32 v16, 16, v30
    v_and_b32 v17, s59, v30
    v_lshlrev_b32 v18, 16, v31
    v_and_b32 v19, s59, v31
    v_lshlrev_b32 v20, 16, v32
    v_and_b32 v21, s59, v32
    v_lshlrev_b32 v22, 16, v33
    v_and_b32 v23, s59, v33
    v_lshlrev_b32 v24, 16, v34
    v_and_b32 v25, s59, v34
    v_lshlrev_b32 v26, 16, v35
    v_and_b32 v27, s59, v35
    s_waitcnt vmcnt(6)
    s_nop 0
    v_mfma_f32_32x32x16_bf16 v[12:27], v[44:47], v[172:175], v[12:27]
    buffer_load_dwordx4 v[200:203], v2, s[8:11], s58 offen offset:3072 sc1
    v_mfma_f32_32x32x16_bf16 v[28:43], v[48:51], v[172:175], 0
    s_lshl_b32 s57, s3, 12
    s_add_u32 s57, s57, 81920
    v_add_u32 v4, s57, v2
    s_waitcnt vmcnt(6)
    v_mfma_f32_32x32x16_bf16 v[12:27], v[52:55], v[176:179], v[12:27]
    s_add_u32 s58, s58, 4096
    buffer_load_dwordx4 v[204:207], v2, s[8:11], s58 offen offset:0 sc1
    v_mfma_f32_32x32x16_bf16 v[28:43], v[56:59], v[176:179], v[28:43]
    v_xor_b32 v5, 8192, v4
    s_lshl_b32 s57, s3, 2
    v_add_u32 v8, s57, v1
    s_waitcnt vmcnt(6)
    v_mfma_f32_32x32x16_bf16 v[12:27], v[60:63], v[180:183], v[12:27]
    buffer_load_dwordx4 v[208:211], v2, s[8:11], s58 offen offset:1024 sc1
    v_mfma_f32_32x32x16_bf16 v[28:43], v[64:67], v[180:183], v[28:43]
    v_xor_b32 v9, 8, v8
    v_lshlrev_b32 v253, 1, v6
    s_lshl_b32 s51, s5, 7
    s_waitcnt vmcnt(6)
    v_mfma_f32_32x32x16_bf16 v[12:27], v[68:71], v[184:187], v[12:27]
    buffer_load_dwordx4 v[212:215], v2, s[8:11], s58 offen offset:2048 sc1
    v_mfma_f32_32x32x16_bf16 v[28:43], v[72:75], v[184:187], v[28:43]
    s_lshl_b32 s57, s60, 6
    s_add_u32 s51, s51, s57
    s_lshl_b32 s52, s5, 14
    s_waitcnt vmcnt(6)
    v_mfma_f32_32x32x16_bf16 v[12:27], v[76:79], v[188:191], v[12:27]
    buffer_load_dwordx4 v[216:219], v2, s[8:11], s58 offen offset:3072 sc1
    v_mfma_f32_32x32x16_bf16 v[28:43], v[80:83], v[188:191], v[28:43]
    s_lshl_b32 s57, s60, 13
    s_add_u32 s52, s52, s57
    s_add_u32 s52, s52, 9961472
    s_waitcnt vmcnt(6)
    v_mfma_f32_32x32x16_bf16 v[12:27], v[84:87], v[192:195], v[12:27]
    s_add_u32 s58, s58, 4096
    buffer_load_dwordx4 v[220:223], v2, s[8:11], s58 offen offset:0 sc1
    v_mfma_f32_32x32x16_bf16 v[28:43], v[88:91], v[192:195], v[28:43]
    s_lshl_b32 s50, s6, 10
    s_lshl_b32 s57, s61, 9
    s_add_u32 s50, s50, s57
    s_waitcnt vmcnt(6)
    v_mfma_f32_32x32x16_bf16 v[12:27], v[92:95], v[196:199], v[12:27]
    buffer_load_dwordx4 v[224:227], v2, s[8:11], s58 offen offset:1024 sc1
    v_mfma_f32_32x32x16_bf16 v[28:43], v[96:99], v[196:199], v[28:43]
    s_add_u32 s50, s50, s52
    v_mov_b32 v237, s4
    v_mov_b32 v239, s4
    s_waitcnt vmcnt(6)
    v_mfma_f32_32x32x16_bf16 v[12:27], v[100:103], v[200:203], v[12:27]
    buffer_load_dwordx4 v[228:231], v2, s[8:11], s58 offen offset:2048 sc1
    v_mfma_f32_32x32x16_bf16 v[28:43], v[104:107], v[200:203], v[28:43]
    s_add_u32 s56, s52, 4096
    s_waitcnt vmcnt(6)
    v_mfma_f32_32x32x16_bf16 v[12:27], v[108:111], v[204:207], v[12:27]
    buffer_load_dwordx4 v[232:235], v2, s[8:11], s58 offen offset:3072 sc1
    v_mfma_f32_32x32x16_bf16 v[28:43], v[112:115], v[204:207], v[28:43]
    s_waitcnt vmcnt(6)
    v_mfma_f32_32x32x16_bf16 v[12:27], v[116:119], v[208:211], v[12:27]
    buffer_load_ushort v252, v253, s[36:39], s51 offen
    v_mov_b32 v3, 1
    s_mov_b64 exec, 1
    ds_add_u32 v1, v3 offset:72
    s_mov_b64 exec, -1
    v_mfma_f32_32x32x16_bf16 v[28:43], v[120:123], v[208:211], v[28:43]
    s_waitcnt vmcnt(6)
    v_mfma_f32_32x32x16_bf16 v[12:27], v[124:127], v[212:215], v[12:27]
    v_mfma_f32_32x32x16_bf16 v[28:43], v[128:131], v[212:215], v[28:43]
    s_waitcnt vmcnt(5)
    v_mfma_f32_32x32x16_bf16 v[12:27], v[132:135], v[216:219], v[12:27]
    v_mfma_f32_32x32x16_bf16 v[28:43], v[136:139], v[216:219], v[28:43]
    s_waitcnt vmcnt(4)
    v_mfma_f32_32x32x16_bf16 v[12:27], v[140:143], v[220:223], v[12:27]
    v_mfma_f32_32x32x16_bf16 v[28:43], v[144:147], v[220:223], v[28:43]
    s_waitcnt vmcnt(3)
    v_mfma_f32_32x32x16_bf16 v[12:27], v[148:151], v[224:227], v[12:27]
    v_mfma_f32_32x32x16_bf16 v[28:43], v[152:155], v[224:227], v[28:43]
    s_waitcnt vmcnt(2)
    v_mfma_f32_32x32x16_bf16 v[12:27], v[156:159], v[228:231], v[12:27]
    v_mfma_f32_32x32x16_bf16 v[28:43], v[160:163], v[228:231], v[28:43]
    s_waitcnt vmcnt(1)
    v_mfma_f32_32x32x16_bf16 v[12:27], v[164:167], v[232:235], v[12:27]
    v_mfma_f32_32x32x16_bf16 v[28:43], v[168:171], v[232:235], v[28:43]
    v_mov_b32 v3, 1
    s_nop 10
    ds_write_b128 v4, v[28:31] offset:0
    ds_write_b128 v4, v[32:35] offset:1024
    ds_write_b128 v4, v[36:39] offset:2048
    ds_write_b128 v4, v[40:43] offset:3072
    ds_write_b32 v8, v3 offset:16
sp_86:
    ds_read_b32 v3, v9 offset:16
    ds_read_b128 v[44:47], v5 offset:0
    ds_read_b128 v[48:51], v5 offset:1024
    ds_read_b128 v[52:55], v5 offset:2048
    ds_read_b128 v[56:59], v5 offset:3072
    s_sub_u32 s47, s47, 1
    s_cselect_b64 s[98:99], -1, 0
    s_andn2_b32 s47, s47, s98
    s_waitcnt lgkmcnt(0)
    v_readfirstlane_b32 s48, v3
    s_nop 0
    s_or_b32 s48, s48, s98
    s_cmp_lt_u32 s48, 1
    s_cbranch_scc1 sp_86
    v_add_f32 v12, v12, v44
    v_add_f32 v13, v13, v45
    v_add_f32 v14, v14, v46
    v_add_f32 v15, v15, v47
    v_add_f32 v16, v16, v48
    v_add_f32 v17, v17, v49
    v_add_f32 v18, v18, v50
    v_add_f32 v19, v19, v51
    v_add_f32 v20, v20, v52
    v_add_f32 v21, v21, v53
    v_add_f32 v22, v22, v54
    v_add_f32 v23, v23, v55
    v_add_f32 v24, v24, v56
    v_add_f32 v25, v25, v57
    v_add_f32 v26, v26, v58
    v_add_f32 v27, v27, v59
    v_add_f32 v236, v12, v13
    v_mul_f32 v238, v12, v12
    v_add_f32 v240, v14, v15
    v_mul_f32 v241, v13, v13
    v_fmac_f32 v238, v14, v14
    v_fmac_f32 v241, v15, v15
    v_fmac_f32 v238, v16, v16
    v_add_f32 v236, v236, v16
    v_fmac_f32 v241, v17, v17
    v_add_f32 v240, v240, v17
    v_fmac_f32 v238, v18, v18
    v_add_f32 v236, v236, v18
    v_fmac_f32 v241, v19, v19
    v_add_f32 v240, v240, v19
    v_fmac_f32 v238, v20, v20
    v_add_f32 v236, v236, v20
    v_fmac_f32 v241, v21, v21
    v_add_f32 v240, v240, v21
    v_fmac_f32 v238, v22, v22
    v_add_f32 v236, v236, v22
    v_fmac_f32 v241, v23, v23
    v_add_f32 v240, v240, v23
    v_fmac_f32 v238, v24, v24
    v_add_f32 v236, v236, v24
    v_fmac_f32 v241, v25, v25
    v_add_f32 v240, v240, v25
    v_fmac_f32 v238, v26, v26
    v_add_f32 v236, v236, v26
    v_fmac_f32 v241, v27, v27
    v_add_f32 v240, v240, v27
    v_add_f32 v236, v236, v240
    v_add_f32 v238, v238, v241
    v_mov_b32 v240, v236
    v_mov_b32 v241, v238
    s_nop 0
    v_permlane32_swap_b32 v236, v240
    v_permlane32_swap_b32 v238, v241
    v_add_f32 v236, v236, v240
    v_add_f32 v238, v238, v241
    s_mov_b32 exec_hi, 0
    s_cmp_lg_u32 s46, 0
    s_cbranch_scc0 sf_87
    buffer_store_dwordx4 v[236:239], v2, s[8:11], s50 offen
sd_88:
    s_mov_b64 exec, -1
    v_and_b32 v242, 15, v0
    v_lshlrev_b32 v242, 9, v242
    v_add_u32 v242, 508, v242
    buffer_load_dword v243, v242, s[8:11], s52 offen sc1
    s_lshl_b32 s58, s3, 11
    s_add_u32 s58, s58, 73728
    v_lshlrev_b32 v4, 6, v6
    v_lshl_add_u32 v4, v7, 3, v4
    v_add_u32 v4, s58, v4
    v_bfe_u32 v5, v0, 2, 4
    v_lshlrev_b32 v5, 6, v5
    v_lshl_add_u32 v5, v11, 3, v5
    v_add_u32 v5, s58, v5
    s_lshl_b32 s50, s60, 15
    s_add_u32 s50, s50, s53
    s_lshl_b32 s51, s6, 12
    s_add_u32 s50, s50, s51
    s_lshl_b32 s51, s61, 11
    s_add_u32 s50, s50, s51
    s_add_u32 s50, s50, 6291456
    s_mov_b32 s57, 0x3b000000
    s_mov_b32 s58, 0x3727c5ac
    s_waitcnt vmcnt(0)
    v_cmp_ne_u32 vcc, s4, v243
    s_nop 0
    s_cmp_eq_u64 vcc, 0
    s_cbranch_scc1 L_gp
pl_89:
    buffer_load_dword v3, v242, s[8:11], s52 offen sc1
    s_sub_u32 s47, s47, 1
    s_cselect_b64 s[98:99], -1, 0
    s_andn2_b32 s47, s47, s98
    s_waitcnt vmcnt(0)
    v_cmp_ne_u32 vcc, s4, v3
    s_nop 0
    s_andn2_b64 vcc, vcc, s[98:99]
    s_cbranch_scc1 pl_89
L_gp:
    buffer_load_dwordx4 v[84:87], v2, s[8:11], s52 offen offset:0 sc1
    buffer_load_dwordx4 v[88:91], v2, s[8:11], s52 offen offset:1024 sc1
    buffer_load_dwordx4 v[92:95], v2, s[8:11], s52 offen offset:2048 sc1
    buffer_load_dwordx4 v[96:99], v2, s[8:11], s52 offen offset:3072 sc1
    buffer_load_dwordx4 v[100:103], v2, s[8:11], s56 offen offset:0 sc1
    buffer_load_dwordx4 v[104:107], v2, s[8:11], s56 offen offset:1024 sc1
    buffer_load_dwordx4 v[108:111], v2, s[8:11], s56 offen offset:2048 sc1
    buffer_load_dwordx4 v[112:115], v2, s[8:11], s56 offen offset:3072 sc1
    s_sub_u32 s47, s47, 1
    s_cselect_b64 s[98:99], -1, 0
    s_andn2_b32 s47, s47, s98
L_gchk:
    s_waitcnt vmcnt(7)
    v_xor_b32 v8, s4, v85
    v_xor_b32 v9, s4, v87
    s_waitcnt vmcnt(6)
    v_bitop3_b32 v8, v8, v89, v237 bitop3:0xf6
    v_bitop3_b32 v9, v9, v91, v237 bitop3:0xf6
    v_add_f32 v84, v84, v88
    v_add_f32 v86, v86, v90
    s_waitcnt vmcnt(5)
    v_bitop3_b32 v8, v8, v93, v237 bitop3:0xf6
    v_bitop3_b32 v9, v9, v95, v237 bitop3:0xf6
    v_add_f32 v84, v84, v92
    v_add_f32 v86, v86, v94
    s_waitcnt vmcnt(4)
    v_bitop3_b32 v8, v8, v97, v237 bitop3:0xf6
    v_bitop3_b32 v9, v9, v99, v237 bitop3:0xf6
    v_add_f32 v84, v84, v96
    v_add_f32 v86, v86, v98
    s_waitcnt vmcnt(3)
    v_bitop3_b32 v8, v8, v101, v237 bitop3:0xf6
    v_bitop3_b32 v9, v9, v103, v237 bitop3:0xf6
    v_add_f32 v84, v84, v100
    v_add_f32 v86, v86, v102
    s_waitcnt vmcnt(2)
    v_bitop3_b32 v8, v8, v105, v237 bitop3:0xf6
    v_bitop3_b32 v9, v9, v107, v237 bitop3:0xf6
    v_add_f32 v84, v84, v104
    v_add_f32 v86, v86, v106
    s_waitcnt vmcnt(1)
    v_bitop3_b32 v8, v8, v109, v237 bitop3:0xf6
    v_bitop3_b32 v9, v9, v111, v237 bitop3:0xf6
    v_add_f32 v84, v84, v108
    v_add_f32 v86, v86, v110
    s_waitcnt vmcnt(0)
    v_bitop3_b32 v8, v8, v113, v237 bitop3:0xf6
    v_bitop3_b32 v9, v9, v115, v237 bitop3:0xf6
    v_add_f32 v84, v84, v112
    v_add_f32 v86, v86, v114
    v_or_b32 v8, v8, v9
    v_mov_b32 v240, v84
    v_mov_b32 v241, v86
    v_cmp_ne_u32 vcc, 0, v8
    s_nop 0
    s_andn2_b64 vcc, vcc, s[98:99]
    s_cbranch_scc1 L_gp
    v_permlane32_swap_b32 v84, v240
    v_permlane32_swap_b32 v86, v241
    v_add_f32 v236, v84, v240
    v_add_f32 v238, v86, v241
    v_mul_f32 v236, s57, v236
    v_mul_f32 v238, s57, v238
    v_fma_f32 v238, -v236, v236, v238
    v_max_f32 v238, 0, v238
    v_add_f32 v240, s58, v238
    v_rsq_f32 v240, v240
    v_lshlrev_b32 v252, 16, v252
    v_mul_f32 v241, v240, v240
    v_fma_f32 v241, v241, v238, s58
    v_rsq_f32 v241, v241
    s_nop 0
    v_mul_f32 v240, v240, v241
    v_mul_f32 v236, v236, v240
    v_fma_f32 v28, v12, v240, -v236
    v_fma_f32 v29, v13, v240, -v236
    v_fma_f32 v30, v14, v240, -v236
    v_fma_f32 v31, v15, v240, -v236
    v_cvt_pk_bf16_f32 v84, v28, v29
    v_cvt_pk_bf16_f32 v85, v30, v31
    ds_write_b64 v4, v[84:85] offset:0
    v_fma_f32 v32, v16, v240, -v236
    v_fma_f32 v33, v17, v240, -v236
    v_fma_f32 v34, v18, v240, -v236
    v_fma_f32 v35, v19, v240, -v236
    v_cvt_pk_bf16_f32 v86, v32, v33
    v_cvt_pk_bf16_f32 v87, v34, v35
    ds_write_b64 v4, v[86:87] offset:16
    ds_read_b64_tr_b16 v[92:93], v5 offset:0
    ds_read_b64_tr_b16 v[94:95], v5 offset:1024
    v_fma_f32 v36, v20, v240, -v236
    v_fma_f32 v37, v21, v240, -v236
    v_fma_f32 v38, v22, v240, -v236
    v_fma_f32 v39, v23, v240, -v236
    v_cvt_pk_bf16_f32 v88, v36, v37
    v_cvt_pk_bf16_f32 v89, v38, v39
    ds_write_b64 v4, v[88:89] offset:32
    v_fma_f32 v40, v24, v240, -v236
    v_fma_f32 v41, v25, v240, -v236
    v_fma_f32 v42, v26, v240, -v236
    v_fma_f32 v43, v27, v240, -v236
    v_cvt_pk_bf16_f32 v90, v40, v41
    v_cvt_pk_bf16_f32 v91, v42, v43
    ds_write_b64 v4, v[90:91] offset:48
    ds_read_b64_tr_b16 v[96:97], v5 offset:32
    ds_read_b64_tr_b16 v[98:99], v5 offset:1056
    s_waitcnt lgkmcnt(4)
    buffer_store_dwordx4 v[92:95], v2, s[8:11], s50 offen sc1
    s_waitcnt lgkmcnt(0)
    buffer_store_dwordx4 v[96:99], v2, s[8:11], s50 offen offset:1024 sc1
    v_mov_b32 v3, 1
    s_mov_b64 exec, 1
    ds_add_u32 v1, v3 offset:72
    s_mov_b64 exec, -1
    v_add_f32 v12, v12, v252
    v_add_f32 v13, v13, v252
    v_add_f32 v14, v14, v252
    v_add_f32 v15, v15, v252
    v_add_f32 v16, v16, v252
    v_add_f32 v17, v17, v252
    v_add_f32 v18, v18, v252
    v_add_f32 v19, v19, v252
    v_add_f32 v20, v20, v252
    v_add_f32 v21, v21, v252
    v_add_f32 v22, v22, v252
    v_add_f32 v23, v23, v252
    v_add_f32 v24, v24, v252
    v_add_f32 v25, v25, v252
    v_add_f32 v26, v26, v252
    v_add_f32 v27, v27, v252
    s_lshl_b32 s57, s60, 5
    v_add_u32 v4, s57, v6
    v_mul_u32_u24 v4, 272, v4
    v_lshl_add_u32 v4, v7, 4, v4
    s_lshl_b32 s57, s61, 7
    s_add_u32 s57, s57, 90112
    v_add_u32 v4, s57, v4
    s_lshl_b32 s57, s6, 9
    s_lshr_b32 s58, s5, 3
    s_lshl_b32 s58, s58, 7
    s_add_u32 s57, s57, s58
    s_and_b32 s58, s5, 7
    s_lshl_b32 s58, s58, 2
    s_add_u32 s57, s57, s58
    s_add_u32 s57, s57, 10551296
    s_waitcnt vmcnt(0)
    v_mov_b32 v3, 1
    s_mov_b64 exec, 1
    ds_add_rtn_u32 v3, v1, v3 offset:32
    s_mov_b64 exec, -1
    s_waitcnt lgkmcnt(0)
    v_readfirstlane_b32 s48, v3
    s_nop 0
    s_cmp_lg_u32 s48, 3
    s_cbranch_scc1 L_nohf
    v_mov_b32 v3, s4
    v_lshlrev_b32 v8, 8, v2
    s_lshr_b32 s48, s6, 2
    s_lshl_b32 exec_lo, 0x55, s48
    s_mov_b32 exec_hi, 0
    buffer_store_dword v3, v8, s[8:11], s57 offen sc1
    s_mov_b64 exec, -1
L_nohf:
    v_bfe_u32 v244, v0, 5, 1
    v_lshlrev_b32 v3, 4, v244
    s_mul_i32 s59, s45, 96
    s_lshl_b32 s58, s7, 5
    s_add_u32 s59, s59, s58
    buffer_load_dwordx4 v[240:243], v3, s[32:35], s59 offen
    v_lshlrev_b32 v244, 9, v244
    v_bfe_u32 v3, v0, 4, 1
    v_lshl_add_u32 v244, v3, 10, v244
    v_and_b32 v3, 15, v0
    v_lshl_add_u32 v244, v3, 4, v244
    s_mul_i32 s63, s45, 3
    s_add_u32 s63, s63, s7
    s_lshl_b32 s63, s63, 14
    s_lshl_b32 s58, s44, 11
    s_add_u32 s63, s63, s58
    s_add_u32 s63, s63, 8388608
    s_lshl_b32 s68, s44, 9
    s_lshr_b32 s58, s45, 3
    s_lshl_b32 s58, s58, 7
    s_add_u32 s68, s68, s58
    s_and_b32 s58, s45, 7
    s_lshl_b32 s58, s58, 2
    s_add_u32 s68, s68, s58
    s_add_u32 s68, s68, 10584064
    s_mul_i32 s56, s3, 22528
    v_add_u32 v244, s56, v244
    v_add_u32 v244, 12288, v244
sp_90:
    ds_read_b32 v3, v1 offset:32
    s_sub_u32 s47, s47, 1
    s_cselect_b64 s[98:99], -1, 0
    s_andn2_b32 s47, s47, s98
    s_waitcnt lgkmcnt(0)
    v_readfirstlane_b32 s48, v3
    s_nop 0
    s_or_b32 s48, s48, s98
    s_cmp_lt_u32 s48, 4
    s_cbranch_scc1 sp_90
    ds_write_b128 v4, v[12:15] offset:0
    ds_write_b128 v4, v[16:19] offset:32
    ds_write_b128 v4, v[20:23] offset:64
    ds_write_b128 v4, v[24:27] offset:96
    v_mul_u32_u24 v11, 144, v6
    v_lshl_add_u32 v11, v7, 4, v11
    v_add_u32 v11, s56, v11
    v_lshl_add_u32 v10, v7, 9, v10
    v_bfe_u32 v9, v0, 3, 1
    v_lshl_add_u32 v4, v9, 6, v10
    v_add_u32 v4, s56, v4
    v_xor_b32 v5, 64, v4
    v_bfe_u32 v3, v0, 3, 3
    v_and_b32 v6, 7, v0
    v_lshlrev_b32 v7, 1, v3
    v_and_b32 v7, 4, v7
    v_xor_b32 v6, v6, v7
    v_lshlrev_b32 v6, 4, v6
    v_lshl_add_u32 v6, v3, 12, v6
    s_mul_i32 s57, s3, 1441792
    s_lshl_b32 s58, s5, 7
    s_add_u32 s57, s57, s58
    v_add_u32 v6, s57, v6
    v_add_u32 v7, 31744, v6
    v_add_u32 v8, 63488, v6
    v_add_u32 v9, 95232, v6
    v_and_b32 v3, 63, v0
    v_min_u32 v3, 7, v3
    s_mul_i32 s57, s3, 7
    s_cmp_eq_u32 s3, 3
    s_addc_u32 s57, s57, 0
    v_add_u32 v3, s57, v3
    v_min_u32 v3, 28, v3
    v_lshrrev_b32 v10, 3, v3
    v_lshlrev_b32 v10, 7, v10
    v_and_b32 v3, 7, v3
    v_lshl_add_u32 v10, v3, 2, v10
    s_lshl_b32 s51, s6, 9
    s_add_u32 s51, s51, 10584064
    s_and_b32 s57, s2, 7
    s_lshl_b32 s57, s57, 12
    s_add_u32 s51, s51, s57
    s_mul_i32 s49, s3, 360448
    s_lshl_b32 s57, s6, 11
    s_add_u32 s49, s49, s57
    s_add_u32 s49, s49, 8388608
    v_add_u32 v254, s3, v1
    s_waitcnt vmcnt(0)
    s_mul_i32 s70, s6, 11
    s_lshr_b32 s70, s70, 3
    s_sub_u32 s73, 10, s70
    s_cmp_eq_u32 s3, 3
    s_cselect_b32 s73, s73, 99
    s_lshl_b32 s71, s70, 15
    s_lshl_b32 s70, s70, 17
    s_add_u32 s72, s49, 360448
    s_mov_b32 s52, 1
    s_cmp_eq_u32 s3, 3
    s_cbranch_scc1 L_nou1
    s_cmp_ge_u32 s45, 32
    s_cbranch_scc1 L_nou1
    s_setprio 3
    s_mov_b32 s58, 0xffff0000
    s_mov_b32 s59, 0xbdd2d3e8
    v_lshlrev_b32 v160, 16, v240
    v_and_b32 v161, s58, v240
    v_lshlrev_b32 v162, 16, v241
    v_and_b32 v163, s58, v241
    v_lshlrev_b32 v164, 16, v242
    v_and_b32 v165, s58, v242
    v_lshlrev_b32 v166, 16, v243
    v_and_b32 v167, s58, v243
    v_mov_b32 v240, 0xc0135761
bw_91:
    ds_read_b32 v3, v1 offset:36
    s_waitcnt lgkmcnt(0)
    v_readfirstlane_b32 s48, v3
    s_nop 0
    s_cmp_lg_u32 s48, 0x80808080
    s_cbranch_scc0 lwd_92
    s_sleep 1
    s_sub_u32 s47, s47, 1
    s_cbranch_scc0 bw_91
    s_mov_b32 s47, 0
lwd_92:
sp_93:
    ds_read_b32 v3, v1 offset:36
    ds_read_b128 v[176:179], v244 offset:0
    ds_read_b128 v[180:183], v244 offset:256
    ds_read_b128 v[184:187], v244 offset:2048
    ds_read_b128 v[188:191], v244 offset:2304
    ds_read_b128 v[192:195], v244 offset:4096
    ds_read_b128 v[196:199], v244 offset:4352
    ds_read_b128 v[200:203], v244 offset:6144
    ds_read_b128 v[204:207], v244 offset:6400
    s_sub_u32 s47, s47, 1
    s_cselect_b64 s[98:99], -1, 0
    s_andn2_b32 s47, s47, s98
    s_waitcnt lgkmcnt(0)
    v_readfirstlane_b32 s48, v3
    s_nop 0
    s_or_b32 s48, s48, s98
    s_cmp_lt_u32 s48, 0x80808080
    s_cbranch_scc1 sp_93
    v_add_f32 v176, v176, v184
    v_add_f32 v177, v177, v185
    v_add_f32 v178, v178, v186
    v_add_f32 v179, v179, v187
    v_add_f32 v180, v180, v188
    v_add_f32 v181, v181, v189
    v_add_f32 v182, v182, v190
    v_add_f32 v183, v183, v191
    v_add_f32 v192, v192, v200
    v_add_f32 v193, v193, v201
    v_add_f32 v194, v194, v202
    v_add_f32 v195, v195, v203
    v_add_f32 v196, v196, v204
    v_add_f32 v197, v197, v205
    v_add_f32 v198, v198, v206
    v_add_f32 v199, v199, v207
    v_add_f32 v160, v160, v176
    v_add_f32 v161, v161, v177
    v_add_f32 v162, v162, v178
    v_add_f32 v163, v163, v179
    v_add_f32 v164, v164, v180
    v_add_f32 v165, v165, v181
    v_add_f32 v166, v166, v182
    v_add_f32 v167, v167, v183
    v_add_f32 v160, v160, v192
    v_add_f32 v161, v161, v193
    v_add_f32 v162, v162, v194
    v_add_f32 v163, v163, v195
    v_add_f32 v164, v164, v196
    v_add_f32 v165, v165, v197
    v_add_f32 v166, v166, v198
    v_add_f32 v167, v167, v199
    v_mul_f32 v168, v160, v160
    v_mul_f32 v169, v161, v161
    v_mul_f32 v170, v162, v162
    v_mul_f32 v171, v163, v163
    v_mul_f32 v172, v164, v164
    v_mul_f32 v173, v165, v165
    v_mul_f32 v174, v166, v166
    v_mul_f32 v175, v167, v167
    v_fma_f32 v168, v168, s59, v240
    v_fma_f32 v169, v169, s59, v240
    v_fma_f32 v170, v170, s59, v240
    v_fma_f32 v171, v171, s59, v240
    v_fma_f32 v172, v172, s59, v240
    v_fma_f32 v173, v173, s59, v240
    v_fma_f32 v174, v174, s59, v240
    v_fma_f32 v175, v175, s59, v240
    v_mul_f32 v168, v168, v160
    v_mul_f32 v169, v169, v161
    v_mul_f32 v170, v170, v162
    v_mul_f32 v171, v171, v163
    v_mul_f32 v172, v172, v164
    v_mul_f32 v173, v173, v165
    v_mul_f32 v174, v174, v166
    v_mul_f32 v175, v175, v167
    v_exp_f32 v168, v168
    v_exp_f32 v169, v169
    v_exp_f32 v170, v170
    v_exp_f32 v171, v171
    v_exp_f32 v172, v172
    v_exp_f32 v173, v173
    v_exp_f32 v174, v174
    v_exp_f32 v175, v175
    v_add_f32 v168, 1.0, v168
    v_add_f32 v169, 1.0, v169
    v_add_f32 v170, 1.0, v170
    v_add_f32 v171, 1.0, v171
    v_add_f32 v172, 1.0, v172
    v_add_f32 v173, 1.0, v173
    v_add_f32 v174, 1.0, v174
    v_add_f32 v175, 1.0, v175
    v_rcp_f32 v168, v168
    v_rcp_f32 v169, v169
    v_rcp_f32 v170, v170
    v_rcp_f32 v171, v171
    v_rcp_f32 v172, v172
    v_rcp_f32 v173, v173
    v_rcp_f32 v174, v174
    v_rcp_f32 v175, v175
    v_mul_f32 v160, v160, v168
    v_mul_f32 v161, v161, v169
    v_mul_f32 v162, v162, v170
    v_mul_f32 v163, v163, v171
    v_mul_f32 v164, v164, v172
    v_mul_f32 v165, v165, v173
    v_mul_f32 v166, v166, v174
    v_mul_f32 v167, v167, v175
    v_cvt_pk_bf16_f32 v176, v160, v161
    v_cvt_pk_bf16_f32 v177, v162, v163
    v_cvt_pk_bf16_f32 v178, v164, v165
    v_cvt_pk_bf16_f32 v179, v166, v167
    buffer_store_dwordx4 v[176:179], v2, s[8:11], s63 offen sc1
    s_mov_b32 s52, 0
L_nou1:
    s_setprio 0
L_gow:
    s_getreg_b32 s48, hwreg(HW_REG_IB_STS, 0, 4)
    s_or_b32 s48, s48, s52
    s_cbranch_scc1 up_94
    s_waitcnt vmcnt(0)
    s_mov_b32 s52, 1
    v_mov_b32 v3, 1
    s_mov_b64 exec, 1
    ds_add_rtn_u32 v3, v1, v3 offset:40
    s_mov_b64 exec, -1
    s_waitcnt lgkmcnt(0)
    v_readfirstlane_b32 s48, v3
    s_nop 0
    s_cmp_lg_u32 s48, 2
    s_cbranch_scc1 up_94
    v_mov_b32 v3, s4
    v_lshlrev_b32 v253, 8, v2
    s_mov_b64 exec, 0xff
    buffer_store_dword v3, v253, s[8:11], s68 offen sc1
    s_mov_b64 exec, -1
up_94:
    ds_read_b32 v3, v1 offset:44
    s_waitcnt lgkmcnt(0)
    v_readfirstlane_b32 s48, v3
    s_nop 0
    s_cmp_lg_u32 s48, 0x80808080
    s_cbranch_scc0 lwd_95
    s_sleep 1
    s_sub_u32 s47, s47, 1
    s_cbranch_scc0 L_gow
    s_mov_b32 s47, 0
lwd_95:
    s_add_u32 m0, s56, 0
    s_mov_b32 s57, s70
    s_add_u32 s70, s70, 131072
    s_cmp_eq_u32 s70, 1441792
    s_cselect_b32 s70, 0, s70
    s_waitcnt vmcnt(4)
    buffer_load_dwordx4 v6, s[28:31], s57 offen offset:0 lds
    buffer_load_dwordx4 v7, s[28:31], s57 offen offset:1024 lds
    s_waitcnt vmcnt(4)
    buffer_load_dwordx4 v8, s[28:31], s57 offen offset:2048 lds
    buffer_load_dwordx4 v9, s[28:31], s57 offen offset:3072 lds
    s_add_u32 m0, s56, 4096
    s_mov_b32 s57, s70
    s_add_u32 s70, s70, 131072
    s_cmp_eq_u32 s70, 1441792
    s_cselect_b32 s70, 0, s70
    s_waitcnt vmcnt(4)
    buffer_load_dwordx4 v6, s[28:31], s57 offen offset:0 lds
    buffer_load_dwordx4 v7, s[28:31], s57 offen offset:1024 lds
    s_waitcnt vmcnt(4)
    buffer_load_dwordx4 v8, s[28:31], s57 offen offset:2048 lds
    buffer_load_dwordx4 v9, s[28:31], s57 offen offset:3072 lds
    s_add_u32 m0, s56, 8192
    s_mov_b32 s57, s70
    s_add_u32 s70, s70, 131072
    s_cmp_eq_u32 s70, 1441792
    s_cselect_b32 s70, 0, s70
    s_waitcnt vmcnt(4)
    buffer_load_dwordx4 v6, s[28:31], s57 offen offset:0 lds
    buffer_load_dwordx4 v7, s[28:31], s57 offen offset:1024 lds
    s_waitcnt vmcnt(4)
    buffer_load_dwordx4 v8, s[28:31], s57 offen offset:2048 lds
    buffer_load_dwordx4 v9, s[28:31], s57 offen offset:3072 lds
    s_waitcnt vmcnt(8)
    s_cmp_lg_u32 s52, 0
    s_cbranch_scc1 up_96
    s_mov_b32 s52, 1
    v_mov_b32 v3, 1
    s_mov_b64 exec, 1
    ds_add_rtn_u32 v3, v1, v3 offset:40
    s_mov_b64 exec, -1
    s_waitcnt lgkmcnt(0)
    v_readfirstlane_b32 s48, v3
    s_nop 0
    s_cmp_lg_u32 s48, 2
    s_cbranch_scc1 up_96
    v_mov_b32 v3, s4
    v_lshlrev_b32 v253, 8, v2
    s_mov_b64 exec, 0xff
    buffer_store_dword v3, v253, s[8:11], s68 offen sc1
    s_mov_b64 exec, -1
up_96:
    ds_read_b64_tr_b16 v[44:45], v4 offset:0
    ds_read_b64_tr_b16 v[46:47], v4 offset:512
    ds_read_b64_tr_b16 v[48:49], v5 offset:0
    ds_read_b64_tr_b16 v[50:51], v5 offset:512
    ds_read_b64_tr_b16 v[52:53], v4 offset:2048
    ds_read_b64_tr_b16 v[54:55], v4 offset:2560
    ds_read_b64_tr_b16 v[56:57], v5 offset:2048
    ds_read_b64_tr_b16 v[58:59], v5 offset:2560
    s_add_u32 m0, s56, 12288
    s_mov_b32 s57, s70
    s_add_u32 s70, s70, 131072
    s_cmp_eq_u32 s70, 1441792
    s_cselect_b32 s70, 0, s70
    s_waitcnt vmcnt(4)
    buffer_load_dwordx4 v6, s[28:31], s57 offen offset:0 lds
    buffer_load_dwordx4 v7, s[28:31], s57 offen offset:1024 lds
    s_waitcnt vmcnt(4)
    buffer_load_dwordx4 v8, s[28:31], s57 offen offset:2048 lds
    buffer_load_dwordx4 v9, s[28:31], s57 offen offset:3072 lds
    s_waitcnt vmcnt(8)
    ds_read_b64_tr_b16 v[60:61], v4 offset:4096
    ds_read_b64_tr_b16 v[62:63], v4 offset:4608
    ds_read_b64_tr_b16 v[64:65], v5 offset:4096
    ds_read_b64_tr_b16 v[66:67], v5 offset:4608
    ds_read_b64_tr_b16 v[68:69], v4 offset:6144
    ds_read_b64_tr_b16 v[70:71], v4 offset:6656
    ds_read_b64_tr_b16 v[72:73], v5 offset:6144
    ds_read_b64_tr_b16 v[74:75], v5 offset:6656
    s_add_u32 m0, s56, 16384
    s_mov_b32 s57, s70
    s_add_u32 s70, s70, 131072
    s_cmp_eq_u32 s70, 1441792
    s_cselect_b32 s70, 0, s70
    buffer_load_dwordx4 v6, s[28:31], s57 offen offset:0 lds
    buffer_load_dwordx4 v7, s[28:31], s57 offen offset:1024 lds
    buffer_load_dwordx4 v8, s[28:31], s57 offen offset:2048 lds
    buffer_load_dwordx4 v9, s[28:31], s57 offen offset:3072 lds
    s_waitcnt vmcnt(8)
    ds_read_b64_tr_b16 v[76:77], v4 offset:8192
    ds_read_b64_tr_b16 v[78:79], v4 offset:8704
    ds_read_b64_tr_b16 v[80:81], v5 offset:8192
    ds_read_b64_tr_b16 v[82:83], v5 offset:8704
    ds_read_b64_tr_b16 v[84:85], v4 offset:10240
    ds_read_b64_tr_b16 v[86:87], v4 offset:10752
    ds_read_b64_tr_b16 v[88:89], v5 offset:10240
    ds_read_b64_tr_b16 v[90:91], v5 offset:10752
    s_waitcnt lgkmcnt(15)
    s_add_u32 m0, s56, 0
    s_mov_b32 s57, s70
    s_add_u32 s70, s70, 131072
    s_cmp_eq_u32 s70, 1441792
    s_cselect_b32 s70, 0, s70
    buffer_load_dwordx4 v6, s[28:31], s57 offen offset:0 lds
    buffer_load_dwordx4 v7, s[28:31], s57 offen offset:1024 lds
    buffer_load_dwordx4 v8, s[28:31], s57 offen offset:2048 lds
    buffer_load_dwordx4 v9, s[28:31], s57 offen offset:3072 lds
    s_waitcnt vmcnt(8)
    ds_read_b64_tr_b16 v[92:93], v4 offset:12288
    ds_read_b64_tr_b16 v[94:95], v4 offset:12800
    ds_read_b64_tr_b16 v[96:97], v5 offset:12288
    ds_read_b64_tr_b16 v[98:99], v5 offset:12800
    ds_read_b64_tr_b16 v[100:101], v4 offset:14336
    ds_read_b64_tr_b16 v[102:103], v4 offset:14848
    ds_read_b64_tr_b16 v[104:105], v5 offset:14336
    ds_read_b64_tr_b16 v[106:107], v5 offset:14848
    s_waitcnt lgkmcnt(15)
    s_add_u32 m0, s56, 4096
    s_mov_b32 s57, s70
    s_add_u32 s70, s70, 131072
    s_cmp_eq_u32 s70, 1441792
    s_cselect_b32 s70, 0, s70
    buffer_load_dwordx4 v6, s[28:31], s57 offen offset:0 lds
    buffer_load_dwordx4 v7, s[28:31], s57 offen offset:1024 lds
    buffer_load_dwordx4 v8, s[28:31], s57 offen offset:2048 lds
    buffer_load_dwordx4 v9, s[28:31], s57 offen offset:3072 lds
    s_waitcnt vmcnt(8)
    ds_read_b64_tr_b16 v[108:109], v4 offset:16384
    ds_read_b64_tr_b16 v[110:111], v4 offset:16896
    ds_read_b64_tr_b16 v[112:113], v5 offset:16384
    ds_read_b64_tr_b16 v[114:115], v5 offset:16896
    ds_read_b64_tr_b16 v[116:117], v4 offset:18432
    ds_read_b64_tr_b16 v[118:119], v4 offset:18944
    ds_read_b64_tr_b16 v[120:121], v5 offset:18432
    ds_read_b64_tr_b16 v[122:123], v5 offset:18944
    s_waitcnt lgkmcnt(15)
    s_add_u32 m0, s56, 8192
    s_mov_b32 s57, s70
    s_add_u32 s70, s70, 131072
    s_cmp_eq_u32 s70, 1441792
    s_cselect_b32 s70, 0, s70
    buffer_load_dwordx4 v6, s[28:31], s57 offen offset:0 lds
    buffer_load_dwordx4 v7, s[28:31], s57 offen offset:1024 lds
    buffer_load_dwordx4 v8, s[28:31], s57 offen offset:2048 lds
    buffer_load_dwordx4 v9, s[28:31], s57 offen offset:3072 lds
    s_waitcnt vmcnt(8)
    ds_read_b64_tr_b16 v[124:125], v4 offset:0
    ds_read_b64_tr_b16 v[126:127], v4 offset:512
    ds_read_b64_tr_b16 v[128:129], v5 offset:0
    ds_read_b64_tr_b16 v[130:131], v5 offset:512
    ds_read_b64_tr_b16 v[132:133], v4 offset:2048
    ds_read_b64_tr_b16 v[134:135], v4 offset:2560
    ds_read_b64_tr_b16 v[136:137], v5 offset:2048
    ds_read_b64_tr_b16 v[138:139], v5 offset:2560
    s_waitcnt lgkmcnt(15)
    s_add_u32 m0, s56, 12288
    s_mov_b32 s57, s70
    s_add_u32 s70, s70, 131072
    s_cmp_eq_u32 s70, 1441792
    s_cselect_b32 s70, 0, s70
    buffer_load_dwordx4 v6, s[28:31], s57 offen offset:0 lds
    buffer_load_dwordx4 v7, s[28:31], s57 offen offset:1024 lds
    buffer_load_dwordx4 v8, s[28:31], s57 offen offset:2048 lds
    buffer_load_dwordx4 v9, s[28:31], s57 offen offset:3072 lds
    s_waitcnt vmcnt(8)
    ds_read_b64_tr_b16 v[140:141], v4 offset:4096
    ds_read_b64_tr_b16 v[142:143], v4 offset:4608
    ds_read_b64_tr_b16 v[144:145], v5 offset:4096
    ds_read_b64_tr_b16 v[146:147], v5 offset:4608
    ds_read_b64_tr_b16 v[148:149], v4 offset:6144
    ds_read_b64_tr_b16 v[150:151], v4 offset:6656
    ds_read_b64_tr_b16 v[152:153], v5 offset:6144
    ds_read_b64_tr_b16 v[154:155], v5 offset:6656
    s_waitcnt lgkmcnt(15)
    buffer_load_dword v253, v10, s[8:11], s51 offen sc1
    s_add_u32 m0, s56, 16384
    s_mov_b32 s57, s70
    s_add_u32 s70, s70, 131072
    s_cmp_eq_u32 s70, 1441792
    s_cselect_b32 s70, 0, s70
    buffer_load_dwordx4 v6, s[28:31], s57 offen offset:0 lds
    buffer_load_dwordx4 v7, s[28:31], s57 offen offset:1024 lds
    buffer_load_dwordx4 v8, s[28:31], s57 offen offset:2048 lds
    buffer_load_dwordx4 v9, s[28:31], s57 offen offset:3072 lds
    s_waitcnt vmcnt(9)
    ds_read_b64_tr_b16 v[156:157], v4 offset:8192
    ds_read_b64_tr_b16 v[158:159], v4 offset:8704
    ds_read_b64_tr_b16 v[160:161], v5 offset:8192
    ds_read_b64_tr_b16 v[162:163], v5 offset:8704
    ds_read_b64_tr_b16 v[164:165], v4 offset:10240
    ds_read_b64_tr_b16 v[166:167], v4 offset:10752
    ds_read_b64_tr_b16 v[168:169], v5 offset:10240
    ds_read_b64_tr_b16 v[170:171], v5 offset:10752
    s_waitcnt lgkmcnt(15)
    s_add_u32 m0, s56, 0
    s_mov_b32 s57, s70
    s_add_u32 s70, s70, 131072
    s_cmp_eq_u32 s70, 1441792
    s_cselect_b32 s70, 0, s70
    buffer_load_dwordx4 v6, s[28:31], s57 offen offset:0 lds
    buffer_load_dwordx4 v7, s[28:31], s57 offen offset:1024 lds
    buffer_load_dwordx4 v8, s[28:31], s57 offen offset:2048 lds
    buffer_load_dwordx4 v9, s[28:31], s57 offen offset:3072 lds
    s_waitcnt vmcnt(9)
    ds_read_b64_tr_b16 v[172:173], v4 offset:12288
    ds_read_b64_tr_b16 v[174:175], v4 offset:12800
    ds_read_b64_tr_b16 v[176:177], v5 offset:12288
    ds_read_b64_tr_b16 v[178:179], v5 offset:12800
    ds_read_b64_tr_b16 v[180:181], v4 offset:14336
    ds_read_b64_tr_b16 v[182:183], v4 offset:14848
    ds_read_b64_tr_b16 v[184:185], v5 offset:14336
    ds_read_b64_tr_b16 v[186:187], v5 offset:14848
    s_waitcnt vmcnt(8)
    v_cmp_ne_u32 vcc, s4, v253
    s_nop 0
    s_cmp_lg_u64 vcc, 0
    s_cbranch_scc1 L_u1c
L_u1:
    s_add_u32 s58, s49, s71
    buffer_load_dwordx4 v[220:223], v2, s[8:11], s58 offen offset:0 sc1
    s_add_u32 s58, s58, 16384
    buffer_load_dwordx4 v[224:227], v2, s[8:11], s58 offen offset:0 sc1
    s_add_u32 s58, s58, 16384
    s_cmp_eq_u32 s58, s72
    s_cselect_b32 s58, s49, s58
    buffer_load_dwordx4 v[228:231], v2, s[8:11], s58 offen offset:0 sc1
    s_add_u32 s58, s58, 16384
    buffer_load_dwordx4 v[232:235], v2, s[8:11], s58 offen offset:0 sc1
    s_add_u32 s58, s58, 16384
    s_cmp_eq_u32 s58, s72
    s_cselect_b32 s58, s49, s58
    s_waitcnt vmcnt(8)
    ds_read_b64_tr_b16 v[188:189], v4 offset:16384
    ds_read_b64_tr_b16 v[190:191], v4 offset:16896
    ds_read_b64_tr_b16 v[192:193], v5 offset:16384
    ds_read_b64_tr_b16 v[194:195], v5 offset:16896
    ds_read_b64_tr_b16 v[196:197], v4 offset:18432
    ds_read_b64_tr_b16 v[198:199], v4 offset:18944
    ds_read_b64_tr_b16 v[200:201], v5 offset:18432
    ds_read_b64_tr_b16 v[202:203], v5 offset:18944
    buffer_load_dwordx4 v[236:239], v2, s[8:11], s58 offen offset:0 sc1
    s_add_u32 s58, s58, 16384
    buffer_load_dwordx4 v[240:243], v2, s[8:11], s58 offen offset:0 sc1
    s_add_u32 s58, s58, 16384
    s_cmp_eq_u32 s58, s72
    s_cselect_b32 s58, s49, s58
    buffer_load_dwordx4 v[244:247], v2, s[8:11], s58 offen offset:0 sc1
    s_add_u32 s58, s58, 16384
    buffer_load_dwordx4 v[248:251], v2, s[8:11], s58 offen offset:0 sc1
    s_add_u32 s58, s58, 16384
    s_cmp_eq_u32 s58, s72
    s_cselect_b32 s58, s49, s58
    s_waitcnt vmcnt(8)
    ds_read_b64_tr_b16 v[204:205], v4 offset:0
    ds_read_b64_tr_b16 v[206:207], v4 offset:512
    ds_read_b64_tr_b16 v[208:209], v5 offset:0
    ds_read_b64_tr_b16 v[210:211], v5 offset:512
    ds_read_b64_tr_b16 v[212:213], v4 offset:2048
    ds_read_b64_tr_b16 v[214:215], v4 offset:2560
    ds_read_b64_tr_b16 v[216:217], v5 offset:2048
    ds_read_b64_tr_b16 v[218:219], v5 offset:2560
    v_bfe_u32 v8, v0, 2, 6
    v_and_b32 v3, 3, v0
    v_mul_u32_u24 v6, 144, v8
    v_lshl_add_u32 v6, v3, 5, v6
    v_add_u32 v6, 9216, v6
    v_mul_u32_u24 v7, 272, v8
    v_lshl_add_u32 v7, v3, 5, v7
    v_add_u32 v7, 90240, v7
    v_lshlrev_b32 v8, 10, v8
    v_lshl_add_u32 v8, v3, 4, v8
    s_add_u32 s50, s53, s54
    s_waitcnt lgkmcnt(0)
    s_waitcnt vmcnt(7)
    v_mfma_f32_32x32x16_bf16 v[12:27], v[220:223], v[44:47], 0
    v_mfma_f32_32x32x16_bf16 v[28:43], v[220:223], v[48:51], 0
    buffer_load_dwordx4 v[220:223], v2, s[8:11], s58 offen offset:0 sc1
    s_add_u32 s58, s58, 16384
    s_waitcnt vmcnt(7)
    v_mfma_f32_32x32x16_bf16 v[12:27], v[224:227], v[52:55], v[12:27]
    v_mfma_f32_32x32x16_bf16 v[28:43], v[224:227], v[56:59], v[28:43]
    buffer_load_dwordx4 v[224:227], v2, s[8:11], s58 offen offset:0 sc1
    s_add_u32 s58, s58, 16384
    s_cmp_eq_u32 s58, s72
    s_cselect_b32 s58, s49, s58
    s_waitcnt vmcnt(7)
    s_cmp_eq_u32 s73, 1
    s_cbranch_scc1 L_es2
    v_mfma_f32_32x32x16_bf16 v[12:27], v[228:231], v[60:63], v[12:27]
    v_mfma_f32_32x32x16_bf16 v[28:43], v[228:231], v[64:67], v[28:43]
L_es2:
    buffer_load_dwordx4 v[228:231], v2, s[8:11], s58 offen offset:0 sc1
    s_add_u32 s58, s58, 16384
    s_waitcnt vmcnt(7)
    s_cmp_eq_u32 s73, 1
    s_cbranch_scc1 L_es3
    v_mfma_f32_32x32x16_bf16 v[12:27], v[232:235], v[68:71], v[12:27]
    v_mfma_f32_32x32x16_bf16 v[28:43], v[232:235], v[72:75], v[28:43]
L_es3:
    buffer_load_dwordx4 v[232:235], v2, s[8:11], s58 offen offset:0 sc1
    s_add_u32 s58, s58, 16384
    s_cmp_eq_u32 s58, s72
    s_cselect_b32 s58, s49, s58
    s_waitcnt vmcnt(7)
    s_cmp_eq_u32 s73, 2
    s_cbranch_scc1 L_es4
    v_mfma_f32_32x32x16_bf16 v[12:27], v[236:239], v[76:79], v[12:27]
    v_mfma_f32_32x32x16_bf16 v[28:43], v[236:239], v[80:83], v[28:43]
L_es4:
    buffer_load_dwordx4 v[236:239], v2, s[8:11], s58 offen offset:0 sc1
    s_add_u32 s58, s58, 16384
    s_waitcnt vmcnt(7)
    s_cmp_eq_u32 s73, 2
    s_cbranch_scc1 L_es5
    v_mfma_f32_32x32x16_bf16 v[12:27], v[240:243], v[84:87], v[12:27]
    v_mfma_f32_32x32x16_bf16 v[28:43], v[240:243], v[88:91], v[28:43]
L_es5:
    buffer_load_dwordx4 v[240:243], v2, s[8:11], s58 offen offset:0 sc1
    s_add_u32 s58, s58, 16384
    s_cmp_eq_u32 s58, s72
    s_cselect_b32 s58, s49, s58
    s_waitcnt vmcnt(7)
    s_cmp_eq_u32 s73, 3
    s_cbranch_scc1 L_es6
    v_mfma_f32_32x32x16_bf16 v[12:27], v[244:247], v[92:95], v[12:27]
    v_mfma_f32_32x32x16_bf16 v[28:43], v[244:247], v[96:99], v[28:43]
L_es6:
    s_add_u32 s51, s51, 131072
    buffer_load_dword v253, v10, s[8:11], s51 offen sc1
    buffer_load_dwordx4 v[244:247], v2, s[8:11], s58 offen offset:0 sc1
    s_add_u32 s58, s58, 16384
    s_waitcnt vmcnt(8)
    s_cmp_eq_u32 s73, 3
    s_cbranch_scc1 L_es7
    v_mfma_f32_32x32x16_bf16 v[12:27], v[248:251], v[100:103], v[12:27]
    v_mfma_f32_32x32x16_bf16 v[28:43], v[248:251], v[104:107], v[28:43]
L_es7:
    buffer_load_dwordx4 v[248:251], v2, s[8:11], s58 offen offset:0 sc1
    s_add_u32 s58, s58, 16384
    s_cmp_eq_u32 s58, s72
    s_cselect_b32 s58, s49, s58
    s_waitcnt vmcnt(8)
    s_cmp_eq_u32 s73, 4
    s_cbranch_scc1 L_es8
    v_mfma_f32_32x32x16_bf16 v[12:27], v[220:223], v[108:111], v[12:27]
    v_mfma_f32_32x32x16_bf16 v[28:43], v[220:223], v[112:115], v[28:43]
L_es8:
    buffer_load_dwordx4 v[220:223], v2, s[8:11], s58 offen offset:0 sc1
    s_add_u32 s58, s58, 16384
    s_waitcnt vmcnt(8)
    s_cmp_eq_u32 s73, 4
    s_cbranch_scc1 L_es9
    v_mfma_f32_32x32x16_bf16 v[12:27], v[224:227], v[116:119], v[12:27]
    v_mfma_f32_32x32x16_bf16 v[28:43], v[224:227], v[120:123], v[28:43]
L_es9:
    buffer_load_dwordx4 v[224:227], v2, s[8:11], s58 offen offset:0 sc1
    s_add_u32 s58, s58, 16384
    s_cmp_eq_u32 s58, s72
    s_cselect_b32 s58, s49, s58
    s_waitcnt vmcnt(8)
    s_cmp_eq_u32 s73, 5
    s_cbranch_scc1 L_es10
    v_mfma_f32_32x32x16_bf16 v[12:27], v[228:231], v[124:127], v[12:27]
    v_mfma_f32_32x32x16_bf16 v[28:43], v[228:231], v[128:131], v[28:43]
L_es10:
    buffer_load_dwordx4 v[228:231], v2, s[8:11], s58 offen offset:0 sc1
    s_add_u32 s58, s58, 16384
    s_waitcnt vmcnt(8)
    s_cmp_eq_u32 s73, 5
    s_cbranch_scc1 L_es11
    v_mfma_f32_32x32x16_bf16 v[12:27], v[232:235], v[132:135], v[12:27]
    v_mfma_f32_32x32x16_bf16 v[28:43], v[232:235], v[136:139], v[28:43]
L_es11:
    buffer_load_dwordx4 v[232:235], v2, s[8:11], s58 offen offset:0 sc1
    s_add_u32 s58, s58, 16384
    s_cmp_eq_u32 s58, s72
    s_cselect_b32 s58, s49, s58
    s_waitcnt vmcnt(8)
    s_cmp_eq_u32 s73, 6
    s_cbranch_scc1 L_es12
    v_mfma_f32_32x32x16_bf16 v[12:27], v[236:239], v[140:143], v[12:27]
    v_mfma_f32_32x32x16_bf16 v[28:43], v[236:239], v[144:147], v[28:43]
L_es12:
    buffer_load_dwordx4 v[236:239], v2, s[8:11], s58 offen offset:0 sc1
    s_add_u32 s58, s58, 16384
    s_waitcnt vmcnt(8)
    s_cmp_eq_u32 s73, 6
    s_cbranch_scc1 L_es13
    v_mfma_f32_32x32x16_bf16 v[12:27], v[240:243], v[148:151], v[12:27]
    v_mfma_f32_32x32x16_bf16 v[28:43], v[240:243], v[152:155], v[28:43]
L_es13:
    buffer_load_dwordx4 v[240:243], v2, s[8:11], s58 offen offset:0 sc1
    s_add_u32 s58, s58, 16384
    s_cmp_eq_u32 s58, s72
    s_cselect_b32 s58, s49, s58
    s_waitcnt vmcnt(7)
    s_cmp_eq_u32 s73, 7
    s_cbranch_scc1 L_es14
    v_mfma_f32_32x32x16_bf16 v[12:27], v[244:247], v[156:159], v[12:27]
    v_mfma_f32_32x32x16_bf16 v[28:43], v[244:247], v[160:163], v[28:43]
L_es14:
    s_waitcnt vmcnt(8)
    v_cmp_ne_u32 vcc, s4, v253
    s_nop 0
    s_cmp_lg_u64 vcc, 0
    s_cbranch_scc1 L_u2c
L_u2:
    buffer_load_dwordx4 v[244:247], v2, s[8:11], s58 offen offset:1024 sc1
    s_add_u32 s58, s58, 16384
    s_waitcnt vmcnt(7)
    s_cmp_eq_u32 s73, 7
    s_cbranch_scc1 L_es15
    v_mfma_f32_32x32x16_bf16 v[12:27], v[248:251], v[164:167], v[12:27]
    v_mfma_f32_32x32x16_bf16 v[28:43], v[248:251], v[168:171], v[28:43]
L_es15:
    buffer_load_dwordx4 v[248:251], v2, s[8:11], s58 offen offset:1024 sc1
    s_add_u32 s58, s58, 16384
    s_cmp_eq_u32 s58, s72
    s_cselect_b32 s58, s49, s58
    s_waitcnt vmcnt(7)
    s_cmp_eq_u32 s73, 8
    s_cbranch_scc1 L_es16
    v_mfma_f32_32x32x16_bf16 v[12:27], v[220:223], v[172:175], v[12:27]
    v_mfma_f32_32x32x16_bf16 v[28:43], v[220:223], v[176:179], v[28:43]
L_es16:
    buffer_load_dwordx4 v[220:223], v2, s[8:11], s58 offen offset:1024 sc1
    s_add_u32 s58, s58, 16384
    s_waitcnt vmcnt(7)
    s_cmp_eq_u32 s73, 8
    s_cbranch_scc1 L_es17
    v_mfma_f32_32x32x16_bf16 v[12:27], v[224:227], v[180:183], v[12:27]
    v_mfma_f32_32x32x16_bf16 v[28:43], v[224:227], v[184:187], v[28:43]
L_es17:
    buffer_load_dwordx4 v[224:227], v2, s[8:11], s58 offen offset:1024 sc1
    s_add_u32 s58, s58, 16384
    s_cmp_eq_u32 s58, s72
    s_cselect_b32 s58, s49, s58
    s_waitcnt vmcnt(7)
    s_cmp_eq_u32 s73, 9
    s_cbranch_scc1 L_es18
    v_mfma_f32_32x32x16_bf16 v[12:27], v[228:231], v[188:191], v[12:27]
    v_mfma_f32_32x32x16_bf16 v[28:43], v[228:231], v[192:195], v[28:43]
L_es18:
    buffer_load_dwordx4 v[228:231], v2, s[8:11], s58 offen offset:1024 sc1
    s_add_u32 s58, s58, 16384
    s_waitcnt vmcnt(7)
    s_cmp_eq_u32 s73, 9
    s_cbranch_scc1 L_es19
    v_mfma_f32_32x32x16_bf16 v[12:27], v[232:235], v[196:199], v[12:27]
    v_mfma_f32_32x32x16_bf16 v[28:43], v[232:235], v[200:203], v[28:43]
L_es19:
    buffer_load_dwordx4 v[232:235], v2, s[8:11], s58 offen offset:1024 sc1
    s_add_u32 s58, s58, 16384
    s_cmp_eq_u32 s58, s72
    s_cselect_b32 s58, s49, s58
    s_waitcnt vmcnt(7)
    s_cmp_eq_u32 s73, 10
    s_cbranch_scc1 L_es20
    v_mfma_f32_32x32x16_bf16 v[12:27], v[236:239], v[204:207], v[12:27]
    v_mfma_f32_32x32x16_bf16 v[28:43], v[236:239], v[208:211], v[28:43]
L_es20:
    buffer_load_dwordx4 v[236:239], v2, s[8:11], s58 offen offset:1024 sc1
    s_add_u32 s58, s58, 16384
    s_waitcnt vmcnt(7)
    s_cmp_eq_u32 s73, 10
    s_cbranch_scc1 L_es21
    v_mfma_f32_32x32x16_bf16 v[12:27], v[240:243], v[212:215], v[12:27]
    v_mfma_f32_32x32x16_bf16 v[28:43], v[240:243], v[216:219], v[28:43]
L_es21:
    buffer_load_dwordx4 v[240:243], v2, s[8:11], s58 offen offset:1024 sc1
    s_add_u32 s58, s58, 16384
    s_cmp_eq_u32 s58, s72
    s_cselect_b32 s58, s49, s58
    v_mov_b32 v3, 0x80
    s_nop 5
    ds_write_b128 v11, v[12:15] offset:0
    ds_write_b128 v11, v[16:19] offset:32
    ds_write_b128 v11, v[20:23] offset:64
    ds_write_b128 v11, v[24:27] offset:96
    ds_write_b128 v11, v[28:31] offset:4608
    ds_write_b128 v11, v[32:35] offset:4640
    ds_write_b128 v11, v[36:39] offset:4672
    ds_write_b128 v11, v[40:43] offset:4704
    ds_write_b8 v254, v3 offset:80
    s_waitcnt lgkmcnt(0)
    s_waitcnt vmcnt(7)
    v_mfma_f32_32x32x16_bf16 v[12:27], v[244:247], v[44:47], 0
    v_mfma_f32_32x32x16_bf16 v[28:43], v[244:247], v[48:51], 0
    buffer_load_dwordx4 v[244:247], v2, s[8:11], s58 offen offset:1024 sc1
    s_add_u32 s58, s58, 16384
    s_waitcnt vmcnt(7)
    v_mfma_f32_32x32x16_bf16 v[12:27], v[248:251], v[52:55], v[12:27]
    v_mfma_f32_32x32x16_bf16 v[28:43], v[248:251], v[56:59], v[28:43]
    buffer_load_dwordx4 v[248:251], v2, s[8:11], s58 offen offset:1024 sc1
    s_add_u32 s58, s58, 16384
    s_cmp_eq_u32 s58, s72
    s_cselect_b32 s58, s49, s58
    s_waitcnt vmcnt(7)
    s_cmp_eq_u32 s73, 1
    s_cbranch_scc1 L_es24
    v_mfma_f32_32x32x16_bf16 v[12:27], v[220:223], v[60:63], v[12:27]
    v_mfma_f32_32x32x16_bf16 v[28:43], v[220:223], v[64:67], v[28:43]
L_es24:
    buffer_load_dwordx4 v[220:223], v2, s[8:11], s58 offen offset:1024 sc1
    s_add_u32 s58, s58, 16384
    s_waitcnt vmcnt(7)
    s_cmp_eq_u32 s73, 1
    s_cbranch_scc1 L_es25
    v_mfma_f32_32x32x16_bf16 v[12:27], v[224:227], v[68:71], v[12:27]
    v_mfma_f32_32x32x16_bf16 v[28:43], v[224:227], v[72:75], v[28:43]
L_es25:
    buffer_load_dwordx4 v[224:227], v2, s[8:11], s58 offen offset:1024 sc1
    s_add_u32 s58, s58, 16384
    s_cmp_eq_u32 s58, s72
    s_cselect_b32 s58, s49, s58
    s_waitcnt vmcnt(7)
    s_cmp_eq_u32 s73, 2
    s_cbranch_scc1 L_es26
    v_mfma_f32_32x32x16_bf16 v[12:27], v[228:231], v[76:79], v[12:27]
    v_mfma_f32_32x32x16_bf16 v[28:43], v[228:231], v[80:83], v[28:43]
L_es26:
    buffer_load_dwordx4 v[228:231], v2, s[8:11], s58 offen offset:1024 sc1
    s_add_u32 s58, s58, 16384
    s_waitcnt vmcnt(7)
    s_cmp_eq_u32 s73, 2
    s_cbranch_scc1 L_es27
    v_mfma_f32_32x32x16_bf16 v[12:27], v[232:235], v[84:87], v[12:27]
    v_mfma_f32_32x32x16_bf16 v[28:43], v[232:235], v[88:91], v[28:43]
L_es27:
    buffer_load_dwordx4 v[232:235], v2, s[8:11], s58 offen offset:1024 sc1
    s_add_u32 s58, s58, 16384
    s_cmp_eq_u32 s58, s72
    s_cselect_b32 s58, s49, s58
    s_waitcnt vmcnt(7)
    s_cmp_eq_u32 s73, 3
    s_cbranch_scc1 L_es28
    v_mfma_f32_32x32x16_bf16 v[12:27], v[236:239], v[92:95], v[12:27]
    v_mfma_f32_32x32x16_bf16 v[28:43], v[236:239], v[96:99], v[28:43]
L_es28:
    buffer_load_dwordx4 v[236:239], v2, s[8:11], s58 offen offset:1024 sc1
    s_add_u32 s58, s58, 16384
    s_waitcnt vmcnt(7)
    s_cmp_eq_u32 s73, 3
    s_cbranch_scc1 L_es29
    v_mfma_f32_32x32x16_bf16 v[12:27], v[240:243], v[100:103], v[12:27]
    v_mfma_f32_32x32x16_bf16 v[28:43], v[240:243], v[104:107], v[28:43]
L_es29:
    buffer_load_dwordx4 v[240:243], v2, s[8:11], s58 offen offset:1024 sc1
    s_add_u32 s58, s58, 16384
    s_cmp_eq_u32 s58, s72
    s_cselect_b32 s58, s49, s58
    s_waitcnt vmcnt(7)
    s_cmp_eq_u32 s73, 4
    s_cbranch_scc1 L_es30
    v_mfma_f32_32x32x16_bf16 v[12:27], v[244:247], v[108:111], v[12:27]
    v_mfma_f32_32x32x16_bf16 v[28:43], v[244:247], v[112:115], v[28:43]
L_es30:
    buffer_load_dwordx4 v[244:247], v2, s[8:11], s58 offen offset:1024 sc1
    s_add_u32 s58, s58, 16384
    s_waitcnt vmcnt(7)
    s_cmp_eq_u32 s73, 4
    s_cbranch_scc1 L_es31
    v_mfma_f32_32x32x16_bf16 v[12:27], v[248:251], v[116:119], v[12:27]
    v_mfma_f32_32x32x16_bf16 v[28:43], v[248:251], v[120:123], v[28:43]
L_es31:
    buffer_load_dwordx4 v[248:251], v2, s[8:11], s58 offen offset:1024 sc1
    s_add_u32 s58, s58, 16384
    s_cmp_eq_u32 s58, s72
    s_cselect_b32 s58, s49, s58
    s_waitcnt vmcnt(7)
    s_cmp_eq_u32 s73, 5
    s_cbranch_scc1 L_es32
    v_mfma_f32_32x32x16_bf16 v[12:27], v[220:223], v[124:127], v[12:27]
    v_mfma_f32_32x32x16_bf16 v[28:43], v[220:223], v[128:131], v[28:43]
L_es32:
    buffer_load_dwordx4 v[220:223], v2, s[8:11], s58 offen offset:1024 sc1
    s_add_u32 s58, s58, 16384
    s_waitcnt vmcnt(7)
    s_cmp_eq_u32 s73, 5
    s_cbranch_scc1 L_es33
    v_mfma_f32_32x32x16_bf16 v[12:27], v[224:227], v[132:135], v[12:27]
    v_mfma_f32_32x32x16_bf16 v[28:43], v[224:227], v[136:139], v[28:43]
L_es33:
    buffer_load_dwordx4 v[224:227], v2, s[8:11], s58 offen offset:1024 sc1
    s_add_u32 s58, s58, 16384
    s_cmp_eq_u32 s58, s72
    s_cselect_b32 s58, s49, s58
    s_waitcnt vmcnt(7)
    s_cmp_eq_u32 s73, 6
    s_cbranch_scc1 L_es34
    v_mfma_f32_32x32x16_bf16 v[12:27], v[228:231], v[140:143], v[12:27]
    v_mfma_f32_32x32x16_bf16 v[28:43], v[228:231], v[144:147], v[28:43]
L_es34:
    buffer_load_dwordx4 v[228:231], v2, s[8:11], s58 offen offset:1024 sc1
    s_add_u32 s58, s58, 16384
    s_waitcnt vmcnt(7)
    s_cmp_eq_u32 s73, 6
    s_cbranch_scc1 L_es35
    v_mfma_f32_32x32x16_bf16 v[12:27], v[232:235], v[148:151], v[12:27]
    v_mfma_f32_32x32x16_bf16 v[28:43], v[232:235], v[152:155], v[28:43]
L_es35:
    buffer_load_dwordx4 v[232:235], v2, s[8:11], s58 offen offset:1024 sc1
    s_add_u32 s58, s58, 16384
    s_cmp_eq_u32 s58, s72
    s_cselect_b32 s58, s49, s58
    s_waitcnt vmcnt(7)
    s_cmp_eq_u32 s73, 7
    s_cbranch_scc1 L_es36
    v_mfma_f32_32x32x16_bf16 v[12:27], v[236:239], v[156:159], v[12:27]
    v_mfma_f32_32x32x16_bf16 v[28:43], v[236:239], v[160:163], v[28:43]
L_es36:
    s_waitcnt vmcnt(6)
    s_cmp_eq_u32 s73, 7
    s_cbranch_scc1 L_es37
    v_mfma_f32_32x32x16_bf16 v[12:27], v[240:243], v[164:167], v[12:27]
    v_mfma_f32_32x32x16_bf16 v[28:43], v[240:243], v[168:171], v[28:43]
L_es37:
    s_waitcnt vmcnt(5)
    s_cmp_eq_u32 s73, 8
    s_cbranch_scc1 L_es38
    v_mfma_f32_32x32x16_bf16 v[12:27], v[244:247], v[172:175], v[12:27]
    v_mfma_f32_32x32x16_bf16 v[28:43], v[244:247], v[176:179], v[28:43]
L_es38:
    s_waitcnt vmcnt(4)
    s_cmp_eq_u32 s73, 8
    s_cbranch_scc1 L_es39
    v_mfma_f32_32x32x16_bf16 v[12:27], v[248:251], v[180:183], v[12:27]
    v_mfma_f32_32x32x16_bf16 v[28:43], v[248:251], v[184:187], v[28:43]
L_es39:
    s_waitcnt vmcnt(3)
    s_cmp_eq_u32 s73, 9
    s_cbranch_scc1 L_es40
    v_mfma_f32_32x32x16_bf16 v[12:27], v[220:223], v[188:191], v[12:27]
    v_mfma_f32_32x32x16_bf16 v[28:43], v[220:223], v[192:195], v[28:43]
L_es40:
    s_waitcnt vmcnt(2)
    s_cmp_eq_u32 s73, 9
    s_cbranch_scc1 L_es41
    v_mfma_f32_32x32x16_bf16 v[12:27], v[224:227], v[196:199], v[12:27]
    v_mfma_f32_32x32x16_bf16 v[28:43], v[224:227], v[200:203], v[28:43]
L_es41:
    s_waitcnt vmcnt(1)
    s_cmp_eq_u32 s73, 10
    s_cbranch_scc1 L_es42
    v_mfma_f32_32x32x16_bf16 v[12:27], v[228:231], v[204:207], v[12:27]
    v_mfma_f32_32x32x16_bf16 v[28:43], v[228:231], v[208:211], v[28:43]
L_es42:
    s_waitcnt vmcnt(0)
    s_cmp_eq_u32 s73, 10
    s_cbranch_scc1 L_es43
    v_mfma_f32_32x32x16_bf16 v[12:27], v[232:235], v[212:215], v[12:27]
    v_mfma_f32_32x32x16_bf16 v[28:43], v[232:235], v[216:219], v[28:43]
L_es43:
    s_nop 7
    v_mov_b32 v3, 0x80
    s_nop 1
    ds_write_b128 v11, v[12:15] offset:9216
    ds_write_b128 v11, v[16:19] offset:9248
    ds_write_b128 v11, v[20:23] offset:9280
    ds_write_b128 v11, v[24:27] offset:9312
    ds_write_b128 v11, v[28:31] offset:13824
    ds_write_b128 v11, v[32:35] offset:13856
    ds_write_b128 v11, v[36:39] offset:13888
    ds_write_b128 v11, v[40:43] offset:13920
    ds_write_b8 v254, v3 offset:84
    v_add_u32 v84, 45056, v6
sp_97:
    ds_read_b32 v3, v1 offset:84
    ds_read_b128 v[44:47], v6 offset:0
    ds_read_b128 v[48:51], v6 offset:16
    ds_read_b128 v[52:55], v6 offset:22528
    ds_read_b128 v[56:59], v6 offset:22544
    ds_read_b128 v[60:63], v84 offset:0
    ds_read_b128 v[64:67], v84 offset:16
    ds_read_b128 v[68:71], v84 offset:22528
    ds_read_b128 v[72:75], v84 offset:22544
    ds_read_b128 v[76:79], v7 offset:0
    ds_read_b128 v[80:83], v7 offset:16
    s_sub_u32 s47, s47, 1
    s_cselect_b64 s[98:99], -1, 0
    s_andn2_b32 s47, s47, s98
    s_waitcnt lgkmcnt(0)
    v_readfirstlane_b32 s48, v3
    s_nop 0
    s_or_b32 s48, s48, s98
    s_cmp_lt_u32 s48, 0x80808080
    s_cbranch_scc1 sp_97
    v_add_f32 v44, v44, v52
    v_add_f32 v45, v45, v53
    v_add_f32 v46, v46, v54
    v_add_f32 v47, v47, v55
    v_add_f32 v48, v48, v56
    v_add_f32 v49, v49, v57
    v_add_f32 v50, v50, v58
    v_add_f32 v51, v51, v59
    v_add_f32 v60, v60, v68
    v_add_f32 v61, v61, v69
    v_add_f32 v62, v62, v70
    v_add_f32 v63, v63, v71
    v_add_f32 v64, v64, v72
    v_add_f32 v65, v65, v73
    v_add_f32 v66, v66, v74
    v_add_f32 v67, v67, v75
    v_add_f32 v44, v44, v76
    v_add_f32 v45, v45, v77
    v_add_f32 v46, v46, v78
    v_add_f32 v47, v47, v79
    v_add_f32 v48, v48, v80
    v_add_f32 v49, v49, v81
    v_add_f32 v50, v50, v82
    v_add_f32 v51, v51, v83
    v_add_f32 v44, v44, v60
    v_add_f32 v45, v45, v61
    v_add_f32 v46, v46, v62
    v_add_f32 v47, v47, v63
    v_add_f32 v48, v48, v64
    v_add_f32 v49, v49, v65
    v_add_f32 v50, v50, v66
    v_add_f32 v51, v51, v67
    v_cvt_pk_bf16_f32 v52, v44, v45
    v_cvt_pk_bf16_f32 v53, v46, v47
    v_cvt_pk_bf16_f32 v54, v48, v49
    v_cvt_pk_bf16_f32 v55, v50, v51
    buffer_store_dwordx4 v[52:55], v8, s[40:43], s50 offen offset:64 sc1
    s_or_b32 s57, s2, s3
    s_cbranch_scc1 L_noep
    s_mov_b32 s57, 10485760
    v_mov_b32 v3, s4
    s_mov_b64 exec, 1
    buffer_store_dword v3, v2, s[8:11], s57 offen sc1
    s_mov_b64 exec, -1
L_noep:
L_end:
    s_endpgm
L_dry0:
L_dry3:
    s_branch L_dry4
L_dry4:
    s_branch L_dry4x
hc_72c:
    ds_read_b32 v3, v254 offset:176
    s_waitcnt lgkmcnt(0)
    v_readfirstlane_b32 s48, v3
    s_nop 0
    s_cmp_lt_u32 s48, 1
    s_cbranch_scc0 hc_72
    s_sub_u32 s47, s47, 1
    s_cbranch_scc0 hc_72c
    s_mov_b32 s47, 0
    s_branch hc_72
L_dry4x:
    s_branch L_dry4xx
hc_74c:
    ds_read_b32 v3, v254 offset:176
    s_waitcnt lgkmcnt(0)
    v_readfirstlane_b32 s48, v3
    s_nop 0
    s_cmp_lt_u32 s48, 2
    s_cbranch_scc0 hc_74
    s_sub_u32 s47, s47, 1
    s_cbranch_scc0 hc_74c
    s_mov_b32 s47, 0
    s_branch hc_74
L_dry4xx:
    s_branch L_dry4xxx
hc_76c:
    ds_read_b32 v3, v254 offset:176
    s_waitcnt lgkmcnt(0)
    v_readfirstlane_b32 s48, v3
    s_nop 0
    s_cmp_lt_u32 s48, 3
    s_cbranch_scc0 hc_76
    s_sub_u32 s47, s47, 1
    s_cbranch_scc0 hc_76c
    s_mov_b32 s47, 0
    s_branch hc_76
L_dry4xxx:
    s_branch L_dry4xxxx
hc_78c:
    ds_read_b32 v3, v254 offset:176
    s_waitcnt lgkmcnt(0)
    v_readfirstlane_b32 s48, v3
    s_nop 0
    s_cmp_lt_u32 s48, 4
    s_cbranch_scc0 hc_78
    s_sub_u32 s47, s47, 1
    s_cbranch_scc0 hc_78c
    s_mov_b32 s47, 0
    s_branch hc_78
L_dry4xxxx:
    s_branch L_dry4xxxxx
L_u1c:
    s_sleep 1
    buffer_load_dword v253, v10, s[8:11], s51 offen sc1
    s_waitcnt vmcnt(0)
    v_cmp_ne_u32 vcc, s4, v253
    s_nop 0
    s_cmp_lg_u64 vcc, 0
    s_cbranch_scc0 L_u1
    s_sub_u32 s47, s47, 1
    s_cbranch_scc0 L_u1c
    s_mov_b32 s47, 0
    s_branch L_u1
L_dry4xxxxx:
    s_branch L_dry4xxxxxx
L_u2c:
    s_sleep 1
    buffer_load_dword v253, v10, s[8:11], s51 offen sc1
    s_waitcnt vmcnt(0)
    v_cmp_ne_u32 vcc, s4, v253
    s_nop 0
    s_cmp_lg_u64 vcc, 0
    s_cbranch_scc0 L_u2
    s_sub_u32 s47, s47, 1
    s_cbranch_scc0 L_u2c
    s_mov_b32 s47, 0
    s_branch L_u2
L_dry4xxxxxx:
    s_setpc_b64 s[96:97]
bt_53:
    ds_read_b32 v3, v1 offset:160
    s_waitcnt lgkmcnt(0)
    v_readfirstlane_b32 s48, v3
    s_nop 0
    s_cmp_lg_u32 s48, 0x80808080
    s_cbranch_scc0 btb_54
    s_sub_u32 s47, s47, 1
    s_cbranch_scc0 bt_53
    s_mov_b32 s47, 0
    s_branch btb_54
bt_56:
    ds_read_b32 v169, v1 offset:164
    s_waitcnt lgkmcnt(0)
    v_readfirstlane_b32 s48, v169
    s_nop 0
    s_cmp_lg_u32 s48, 0x80808080
    s_cbranch_scc0 btb_57
    s_sub_u32 s47, s47, 1
    s_cbranch_scc0 bt_56
    s_mov_b32 s47, 0
    s_branch btb_57
bt_59:
    ds_read_b32 v169, v1 offset:168
    s_waitcnt lgkmcnt(0)
    v_readfirstlane_b32 s48, v169
    s_nop 0
    s_cmp_lg_u32 s48, 0x80808080
    s_cbranch_scc0 btb_60
    s_sub_u32 s47, s47, 1
    s_cbranch_scc0 bt_59
    s_mov_b32 s47, 0
    s_branch btb_60
bt_62:
    ds_read_b32 v170, v1 offset:116
    s_waitcnt lgkmcnt(0)
    v_readfirstlane_b32 s48, v170
    s_nop 0
    s_cmp_lg_u32 s48, 0x80808080
    s_cbranch_scc0 btb_63
    s_sub_u32 s47, s47, 1
    s_cbranch_scc0 bt_62
    s_mov_b32 s47, 0
    s_branch btb_63
bt_65:
    ds_read_b32 v169, v1 offset:172
    s_waitcnt lgkmcnt(0)
    v_readfirstlane_b32 s48, v169
    s_nop 0
    s_cmp_lg_u32 s48, 0x80808080
    s_cbranch_scc0 btb_66
    s_sub_u32 s47, s47, 1
    s_cbranch_scc0 bt_65
    s_mov_b32 s47, 0
    s_branch btb_66
bt_68:
    ds_read_b32 v170, v1 offset:112
    s_waitcnt lgkmcnt(0)
    v_readfirstlane_b32 s48, v170
    s_nop 0
    s_cmp_lg_u32 s48, 0x80808080
    s_cbranch_scc0 btb_69
    s_sub_u32 s47, s47, 1
    s_cbranch_scc0 bt_68
    s_mov_b32 s47, 0
    s_branch btb_69
L_exit8:
    ds_write_b32 v254, v1 offset:192
    s_branch L_bdone
L_exit6:
    s_nop 1
    v_mfma_f32_32x32x16_bf16 v[236:251], v[112:115], v[208:211], v[236:251]
    s_branch L_exit8
L_exit4:
    s_nop 1
    v_mfma_f32_32x32x16_bf16 v[236:251], v[96:99], v[208:211], v[236:251]
    s_branch L_bdone
L_exit2:
    s_nop 1
    v_mfma_f32_32x32x16_bf16 v[236:251], v[80:83], v[208:211], v[236:251]
    s_branch L_bdone
sf_80:
    buffer_store_dwordx4 v[204:207], v2, s[8:11], s57 offen sc1
    buffer_store_dwordx4 v[208:211], v2, s[8:11], s58 offen sc1
    s_branch sd_81
sf_83:
    buffer_store_dword v3, v2, s[8:11], s57 offen sc1
    s_branch sd_84
sf_87:
    buffer_store_dwordx4 v[236:239], v2, s[8:11], s50 offen sc1
    s_branch sd_88
L_fallback:
    s_cmp_lg_u32 s56, 0
    s_cbranch_scc1 L_bok
    s_mov_b32 s56, 1
    s_waitcnt lgkmcnt(0)
    v_cndmask_b32 v140, v10, v11, s[64:65]
    v_cndmask_b32 v141, v10, v11, s[66:67]
    v_cndmask_b32 v142, v10, v11, s[68:69]
    v_cndmask_b32 v143, v10, v11, s[70:71]
    v_cndmask_b32 v144, v10, v11, s[72:73]
    v_cndmask_b32 v145, v10, v11, s[74:75]
    v_cndmask_b32 v146, v10, v11, s[76:77]
    v_cndmask_b32 v147, v10, v11, s[78:79]
    v_cndmask_b32 v148, v10, v11, s[80:81]
    v_cndmask_b32 v149, v10, v11, s[82:83]
    v_cndmask_b32 v150, v10, v11, s[84:85]
    v_cndmask_b32 v151, v10, v11, s[86:87]
    v_cndmask_b32 v152, v10, v11, s[88:89]
    v_cndmask_b32 v153, v10, v11, s[90:91]
    v_cndmask_b32 v154, v10, v11, s[92:93]
    v_cndmask_b32 v155, v10, v11, s[94:95]
    s_nop 1
    v_mfma_f32_32x32x16_bf16 v[140:155], v[52:55], v[12:15], v[140:155]
    s_nop 11
    v_max_f32 v6, v140, v141
    v_max3_f32 v6, v142, v143, v6
    v_max3_f32 v6, v144, v145, v6
    v_max3_f32 v6, v146, v147, v6
    v_max3_f32 v6, v148, v149, v6
    v_max3_f32 v6, v150, v151, v6
    v_max3_f32 v6, v152, v153, v6
    v_max3_f32 v6, v154, v155, v6
    v_cndmask_b32 v140, v10, v11, s[64:65]
    v_cndmask_b32 v141, v10, v11, s[66:67]
    v_cndmask_b32 v142, v10, v11, s[68:69]
    v_cndmask_b32 v143, v10, v11, s[70:71]
    v_cndmask_b32 v144, v10, v11, s[72:73]
    v_cndmask_b32 v145, v10, v11, s[74:75]
    v_cndmask_b32 v146, v10, v11, s[76:77]
    v_cndmask_b32 v147, v10, v11, s[78:79]
    v_cndmask_b32 v148, v10, v11, s[80:81]
    v_cndmask_b32 v149, v10, v11, s[82:83]
    v_cndmask_b32 v150, v10, v11, s[84:85]
    v_cndmask_b32 v151, v10, v11, s[86:87]
    v_cndmask_b32 v152, v10, v11, s[88:89]
    v_cndmask_b32 v153, v10, v11, s[90:91]
    v_cndmask_b32 v154, v10, v11, s[92:93]
    v_cndmask_b32 v155, v10, v11, s[94:95]
    s_nop 1
    v_mfma_f32_32x32x16_bf16 v[140:155], v[56:59], v[16:19], v[140:155]
    s_nop 11
    v_max_f32 v7, v140, v141
    v_max3_f32 v7, v142, v143, v7
    v_max3_f32 v7, v144, v145, v7
    v_max3_f32 v7, v146, v147, v7
    v_max3_f32 v7, v148, v149, v7
    v_max3_f32 v7, v150, v151, v7
    v_max3_f32 v7, v152, v153, v7
    v_max3_f32 v7, v154, v155, v7
    v_mfma_f32_32x32x16_bf16 v[140:155], v[52:55], v[16:19], 0
    s_nop 11
    v_max3_f32 v7, v140, v141, v7
    v_max3_f32 v7, v142, v143, v7
    v_max3_f32 v7, v144, v145, v7
    v_max3_f32 v7, v146, v147, v7
    v_max3_f32 v7, v148, v149, v7
    v_max3_f32 v7, v150, v151, v7
    v_max3_f32 v7, v152, v153, v7
    v_max3_f32 v7, v154, v155, v7
    s_cmp_eq_u32 s5, 0
    s_cbranch_scc1 L_fb2
    v_mfma_f32_32x32x16_bf16 v[140:155], v[48:51], v[12:15], 0
    s_nop 11
    v_max3_f32 v6, v140, v141, v6
    v_max3_f32 v6, v142, v143, v6
    v_max3_f32 v6, v144, v145, v6
    v_max3_f32 v6, v146, v147, v6
    v_max3_f32 v6, v148, v149, v6
    v_max3_f32 v6, v150, v151, v6
    v_max3_f32 v6, v152, v153, v6
    v_max3_f32 v6, v154, v155, v6
    v_mfma_f32_32x32x16_bf16 v[140:155], v[48:51], v[16:19], 0
    s_nop 11
    v_max3_f32 v7, v140, v141, v7
    v_max3_f32 v7, v142, v143, v7
    v_max3_f32 v7, v144, v145, v7
    v_max3_f32 v7, v146, v147, v7
    v_max3_f32 v7, v148, v149, v7
    v_max3_f32 v7, v150, v151, v7
    v_max3_f32 v7, v152, v153, v7
    v_max3_f32 v7, v154, v155, v7
    v_mfma_f32_32x32x16_bf16 v[140:155], v[44:47], v[12:15], 0
    s_nop 11
    v_max3_f32 v6, v140, v141, v6
    v_max3_f32 v6, v142, v143, v6
    v_max3_f32 v6, v144, v145, v6
    v_max3_f32 v6, v146, v147, v6
    v_max3_f32 v6, v148, v149, v6
    v_max3_f32 v6, v150, v151, v6
    v_max3_f32 v6, v152, v153, v6
    v_max3_f32 v6, v154, v155, v6
    v_mfma_f32_32x32x16_bf16 v[140:155], v[44:47], v[16:19], 0
    s_nop 11
    v_max3_f32 v7, v140, v141, v7
    v_max3_f32 v7, v142, v143, v7
    v_max3_f32 v7, v144, v145, v7
    v_max3_f32 v7, v146, v147, v7
    v_max3_f32 v7, v148, v149, v7
    v_max3_f32 v7, v150, v151, v7
    v_max3_f32 v7, v152, v153, v7
    v_max3_f32 v7, v154, v155, v7
    s_cmp_eq_u32 s5, 1
    s_cbranch_scc1 L_fb2
    v_mfma_f32_32x32x16_bf16 v[140:155], v[40:43], v[12:15], 0
    s_nop 11
    v_max3_f32 v6, v140, v141, v6
    v_max3_f32 v6, v142, v143, v6
    v_max3_f32 v6, v144, v145, v6
    v_max3_f32 v6, v146, v147, v6
    v_max3_f32 v6, v148, v149, v6
    v_max3_f32 v6, v150, v151, v6
    v_max3_f32 v6, v152, v153, v6
    v_max3_f32 v6, v154, v155, v6
    v_mfma_f32_32x32x16_bf16 v[140:155], v[40:43], v[16:19], 0
    s_nop 11
    v_max3_f32 v7, v140, v141, v7
    v_max3_f32 v7, v142, v143, v7
    v_max3_f32 v7, v144, v145, v7
    v_max3_f32 v7, v146, v147, v7
    v_max3_f32 v7, v148, v149, v7
    v_max3_f32 v7, v150, v151, v7
    v_max3_f32 v7, v152, v153, v7
    v_max3_f32 v7, v154, v155, v7
    v_mfma_f32_32x32x16_bf16 v[140:155], v[36:39], v[12:15], 0
    s_nop 11
    v_max3_f32 v6, v140, v141, v6
    v_max3_f32 v6, v142, v143, v6
    v_max3_f32 v6, v144, v145, v6
    v_max3_f32 v6, v146, v147, v6
    v_max3_f32 v6, v148, v149, v6
    v_max3_f32 v6, v150, v151, v6
    v_max3_f32 v6, v152, v153, v6
    v_max3_f32 v6, v154, v155, v6
    v_mfma_f32_32x32x16_bf16 v[140:155], v[36:39], v[16:19], 0
    s_nop 11
    v_max3_f32 v7, v140, v141, v7
    v_max3_f32 v7, v142, v143, v7
    v_max3_f32 v7, v144, v145, v7
    v_max3_f32 v7, v146, v147, v7
    v_max3_f32 v7, v148, v149, v7
    v_max3_f32 v7, v150, v151, v7
    v_max3_f32 v7, v152, v153, v7
    v_max3_f32 v7, v154, v155, v7
    s_cmp_eq_u32 s5, 2
    s_cbranch_scc1 L_fb2
    v_mfma_f32_32x32x16_bf16 v[140:155], v[32:35], v[12:15], 0
    s_nop 11
    v_max3_f32 v6, v140, v141, v6
    v_max3_f32 v6, v142, v143, v6
    v_max3_f32 v6, v144, v145, v6
    v_max3_f32 v6, v146, v147, v6
    v_max3_f32 v6, v148, v149, v6
    v_max3_f32 v6, v150, v151, v6
    v_max3_f32 v6, v152, v153, v6
    v_max3_f32 v6, v154, v155, v6
    v_mfma_f32_32x32x16_bf16 v[140:155], v[32:35], v[16:19], 0
    s_nop 11
    v_max3_f32 v7, v140, v141, v7
    v_max3_f32 v7, v142, v143, v7
    v_max3_f32 v7, v144, v145, v7
    v_max3_f32 v7, v146, v147, v7
    v_max3_f32 v7, v148, v149, v7
    v_max3_f32 v7, v150, v151, v7
    v_max3_f32 v7, v152, v153, v7
    v_max3_f32 v7, v154, v155, v7
    v_mfma_f32_32x32x16_bf16 v[140:155], v[28:31], v[12:15], 0
    s_nop 11
    v_max3_f32 v6, v140, v141, v6
    v_max3_f32 v6, v142, v143, v6
    v_max3_f32 v6, v144, v145, v6
    v_max3_f32 v6, v146, v147, v6
    v_max3_f32 v6, v148, v149, v6
    v_max3_f32 v6, v150, v151, v6
    v_max3_f32 v6, v152, v153, v6
    v_max3_f32 v6, v154, v155, v6
    v_mfma_f32_32x32x16_bf16 v[140:155], v[28:31], v[16:19], 0
    s_nop 11
    v_max3_f32 v7, v140, v141, v7
    v_max3_f32 v7, v142, v143, v7
    v_max3_f32 v7, v144, v145, v7
    v_max3_f32 v7, v146, v147, v7
    v_max3_f32 v7, v148, v149, v7
    v_max3_f32 v7, v150, v151, v7
    v_max3_f32 v7, v152, v153, v7
    v_max3_f32 v7, v154, v155, v7
    s_cmp_eq_u32 s5, 3
    s_cbranch_scc1 L_fb2
    v_mfma_f32_32x32x16_bf16 v[140:155], v[24:27], v[12:15], 0
    s_nop 11
    v_max3_f32 v6, v140, v141, v6
    v_max3_f32 v6, v142, v143, v6
    v_max3_f32 v6, v144, v145, v6
    v_max3_f32 v6, v146, v147, v6
    v_max3_f32 v6, v148, v149, v6
    v_max3_f32 v6, v150, v151, v6
    v_max3_f32 v6, v152, v153, v6
    v_max3_f32 v6, v154, v155, v6
    v_cndmask_b32 v140, v11, v10, s[64:65]
    v_cndmask_b32 v141, v11, v10, s[66:67]
    v_cndmask_b32 v142, v11, v10, s[68:69]
    v_cndmask_b32 v143, v11, v10, s[70:71]
    v_cndmask_b32 v144, v11, v10, s[72:73]
    v_cndmask_b32 v145, v11, v10, s[74:75]
    v_cndmask_b32 v146, v11, v10, s[76:77]
    v_cndmask_b32 v147, v11, v10, s[78:79]
    v_cndmask_b32 v148, v11, v10, s[80:81]
    v_cndmask_b32 v149, v11, v10, s[82:83]
    v_cndmask_b32 v150, v11, v10, s[84:85]
    v_cndmask_b32 v151, v11, v10, s[86:87]
    v_cndmask_b32 v152, v11, v10, s[88:89]
    v_cndmask_b32 v153, v11, v10, s[90:91]
    v_cndmask_b32 v154, v11, v10, s[92:93]
    v_cndmask_b32 v155, v11, v10, s[94:95]
    s_nop 1
    v_mfma_f32_32x32x16_bf16 v[140:155], v[24:27], v[16:19], v[140:155]
    s_nop 11
    v_max3_f32 v7, v140, v141, v7
    v_max3_f32 v7, v142, v143, v7
    v_max3_f32 v7, v144, v145, v7
    v_max3_f32 v7, v146, v147, v7
    v_max3_f32 v7, v148, v149, v7
    v_max3_f32 v7, v150, v151, v7
    v_max3_f32 v7, v152, v153, v7
    v_max3_f32 v7, v154, v155, v7
    v_cndmask_b32 v140, v11, v10, s[64:65]
    v_cndmask_b32 v141, v11, v10, s[66:67]
    v_cndmask_b32 v142, v11, v10, s[68:69]
    v_cndmask_b32 v143, v11, v10, s[70:71]
    v_cndmask_b32 v144, v11, v10, s[72:73]
    v_cndmask_b32 v145, v11, v10, s[74:75]
    v_cndmask_b32 v146, v11, v10, s[76:77]
    v_cndmask_b32 v147, v11, v10, s[78:79]
    v_cndmask_b32 v148, v11, v10, s[80:81]
    v_cndmask_b32 v149, v11, v10, s[82:83]
    v_cndmask_b32 v150, v11, v10, s[84:85]
    v_cndmask_b32 v151, v11, v10, s[86:87]
    v_cndmask_b32 v152, v11, v10, s[88:89]
    v_cndmask_b32 v153, v11, v10, s[90:91]
    v_cndmask_b32 v154, v11, v10, s[92:93]
    v_cndmask_b32 v155, v11, v10, s[94:95]
    s_nop 1
    v_mfma_f32_32x32x16_bf16 v[140:155], v[20:23], v[12:15], v[140:155]
    s_nop 11
    v_max3_f32 v6, v140, v141, v6
    v_max3_f32 v6, v142, v143, v6
    v_max3_f32 v6, v144, v145, v6
    v_max3_f32 v6, v146, v147, v6
    v_max3_f32 v6, v148, v149, v6
    v_max3_f32 v6, v150, v151, v6
    v_max3_f32 v6, v152, v153, v6
    v_max3_f32 v6, v154, v155, v6
L_fb2:
    v_mov_b32 v9, v6
    s_nop 1
    v_permlane32_swap_b32 v6, v9
    v_max_f32 v6, v6, v9
    v_sub_f32 v172, 0, v6
    v_sub_f32 v173, 0, v6
    v_sub_f32 v174, 0, v6
    v_sub_f32 v175, 0, v6
    v_sub_f32 v176, 0, v6
    v_sub_f32 v177, 0, v6
    v_sub_f32 v178, 0, v6
    v_sub_f32 v179, 0, v6
    v_sub_f32 v180, 0, v6
    v_sub_f32 v181, 0, v6
    v_sub_f32 v182, 0, v6
    v_sub_f32 v183, 0, v6
    v_sub_f32 v184, 0, v6
    v_sub_f32 v185, 0, v6
    v_sub_f32 v186, 0, v6
    v_sub_f32 v187, 0, v6
    v_mov_b32 v9, v7
    s_nop 1
    v_permlane32_swap_b32 v7, v9
    v_max_f32 v7, v7, v9
    v_sub_f32 v188, 0, v7
    v_sub_f32 v189, 0, v7
    v_sub_f32 v190, 0, v7
    v_sub_f32 v191, 0, v7
    v_sub_f32 v192, 0, v7
    v_sub_f32 v193, 0, v7
    v_sub_f32 v194, 0, v7
    v_sub_f32 v195, 0, v7
    v_sub_f32 v196, 0, v7
    v_sub_f32 v197, 0, v7
    v_sub_f32 v198, 0, v7
    v_sub_f32 v199, 0, v7
    v_sub_f32 v200, 0, v7
    v_sub_f32 v201, 0, v7
    v_sub_f32 v202, 0, v7
    v_sub_f32 v203, 0, v7
    s_nop 1
    s_branch L_redo
.fill 64, 4, 0xbf800000
.section .rodata,"a"
.p2align 6
.amdhsa_kernel sequential_preLN__sliding_block__mixer_token_mlp__prompt_kernel
  .amdhsa_next_free_vgpr 256
  .amdhsa_next_free_sgpr 102
  .amdhsa_accum_offset 256
  .amdhsa_group_segment_fixed_size 0
  .amdhsa_kernarg_size 88
  .amdhsa_user_sgpr_count 2
  .amdhsa_user_sgpr_kernarg_segment_ptr 1
  .amdhsa_system_sgpr_workgroup_id_x 1
  .amdhsa_float_denorm_mode_32 3
.end_amdhsa_kernel
```
